```python
import torch

def _softmax(x, axis=-1):
    return torch.softmax(x, dim=axis)
def _gelu(x):
    return torch.nn.functional.gelu(x, approximate="tanh")
def _silu(x):
    return torch.nn.functional.silu(x)
def _sigmoid(x):
    return torch.sigmoid(x)
def _layernorm(x, axis=-1, eps=1e-5):
    m = x.mean(dim=axis, keepdim=True)
    v = x.var(dim=axis, keepdim=True, unbiased=False)
    return (x - m) / torch.sqrt(v + eps)
def _scatter_add(tgt, idx, src, axis=0):
    return tgt.clone().index_add_(axis, idx, src)
def _segment_sum(src, seg, n):
    out = torch.zeros((n,) + src.shape[1:], dtype=src.dtype)
    return out.index_add_(0, seg, src)
def _pad(x, pw):
    flat = tuple(v for pair in reversed(pw) for v in pair)
    return torch.nn.functional.pad(x, flat)

kernel_name = 'gated_mix__compressed_kv_cla__glu_gated_glu__decode'

def setup_inputs():

    _w = (lambda a: (lambda t: t.to(torch.bfloat16) if t.is_floating_point() else t)(torch.as_tensor(a)))
    def _A_setup():
        B, H, Sq, Sk, D, M = 1, 32, 1, 8192, 192, 640
        Dc = 4 * D
        return {
            "x": _w((lambda *s: torch.randn(*s, dtype=torch.bfloat16) * 0.05)(B, Sq, M)),
            "c_kv": _w((lambda *s: torch.randn(*s, dtype=torch.bfloat16) * 1.6)(B, Sk, Dc)),
            "w_q": _w((lambda *s: torch.randn(*s, dtype=torch.bfloat16) * 3.2)(M, H, D) * (M ** -0.5)),
            "w_uk": _w((lambda *s: torch.randn(*s, dtype=torch.bfloat16) * 3.2)(Dc, H, D) * (Dc ** -0.5)),
            "w_uv": _w((lambda *s: torch.randn(*s, dtype=torch.bfloat16) * 1.6)(Dc, H, D) * (Dc ** -0.5)),
            "w_o": _w((lambda *s: torch.randn(*s, dtype=torch.bfloat16) * 1.6)(H, D, M) * ((H * D) ** -0.5)),
        }
    _A_in = _A_setup()

    def _B_setup():
        B, S, D, F = 1, 1, 640, 1536
        return {
            "x": _w((lambda *s: torch.randn(*s, dtype=torch.bfloat16) * 0.05)(B, S, D)),
            "w_gate": _w((lambda *s: torch.randn(*s, dtype=torch.bfloat16) * 1.6)(D, F)),
            "w_up": _w((lambda *s: torch.randn(*s, dtype=torch.bfloat16) * 0.05)(D, F)),
            "w_down": _w((lambda *s: torch.randn(*s, dtype=torch.bfloat16) * 0.05)(F, D)),
        }
    _B_in = _B_setup()

    return {
        "A_x": _A_in["x"],
        "A_c_kv": _A_in["c_kv"],
        "A_w_q": _A_in["w_q"],
        "A_w_uk": _A_in["w_uk"],
        "A_w_uv": _A_in["w_uv"],
        "A_w_o": _A_in["w_o"],
        "B_x": _B_in["x"],
        "B_w_gate": _B_in["w_gate"],
        "B_w_up": _B_in["w_up"],
        "B_w_down": _B_in["w_down"],
        "gate_w": _w((lambda *s: torch.randn(*s, dtype=torch.bfloat16) * 0.05)(640) * 16.0),
    }

def reference(A_x, A_c_kv, A_w_q, A_w_uk, A_w_uv, A_w_o, B_x, B_w_gate, B_w_up, B_w_down, gate_w):
    def _A_ref(x, c_kv, w_q, w_uk, w_uv, w_o):
        B, Sq, M = x.shape[0], x.shape[1], x.shape[2]
        Sk = c_kv.shape[1]
        H, D = w_q.shape[1], w_q.shape[2]
        q = torch.einsum("bqm,mhd->bhqd", x, w_q)
        k = torch.einsum("bkc,chd->bhkd", c_kv, w_uk)
        v = torch.einsum("bkc,chd->bhkd", c_kv, w_uv)
        scores = torch.einsum("bhqd,bhkd->bhqk", q, k) * (D ** -0.5)
        off = Sk - Sq
        qi = torch.arange(Sq)[:, None]
        kj = torch.arange(Sk)[None, :]
        cmask = kj <= (qi + off)
        scores = torch.where(cmask[None, None], scores, -1e9)
        p = _softmax(scores, axis=-1)
        ctx = torch.einsum("bhqk,bhkd->bhqd", p, v)
        return torch.einsum("bhqd,hdm->bqm", ctx, w_o)

    def _B_ref(x, w_gate, w_up, w_down):
        g = torch.einsum("bsd,df->bsf", x, w_gate)
        u = torch.einsum("bsd,df->bsf", x, w_up)
        h = _sigmoid(g) * u
        return torch.einsum("bsf,fd->bsd", h, w_down)

    x = A_x
    g = _sigmoid((x * gate_w).sum(-1, keepdims=True))
    a = _A_ref(x, A_c_kv, A_w_q, A_w_uk, A_w_uv, A_w_o)
    b = _B_ref(x, B_w_gate, B_w_up, B_w_down)
    return g * a + (1 - g) * b
```

```asm
; @launch grid=(256,1,1) block=(512,1,1) lds=163840
.amdgcn_target "amdgcn-amd-amdhsa--gfx950"
.text
.globl gated_mix__compressed_kv_cla__glu_gated_glu__decode_kernel
.p2align 8
.type gated_mix__compressed_kv_cla__glu_gated_glu__decode_kernel,@function
gated_mix__compressed_kv_cla__glu_gated_glu__decode_kernel:
    s_cmp_ge_u32 s2, 256
    s_cbranch_scc1 L_exit
    s_load_dwordx16 s[76:91], s[0:1], 0
    s_load_dwordx8 s[92:99], s[0:1], 64
    s_load_dwordx2 s[64:65], s[0:1], 104
    v_lshrrev_b32 v2, 6, v0
    v_and_b32 v1, 63, v0
    v_readfirstlane_b32 s3, v2
    s_lshr_b32 s5, s2, 3
    s_and_b32 s5, s5, 15
    s_and_b32 s9, s5, 7
    s_lshl_b32 s9, s9, 3
    s_add_u32 s9, s9, s3
    s_cmp_lg_u32 s9, 7
    s_cbranch_scc1 L_npf_1
    s_getpc_b64 s[40:41]
    v_lshlrev_b32 v252, 4, v1
    s_mov_b32 s9, 17
L_pfl_2:
    global_load_dwordx4 v[248:251], v252, s[40:41]
    v_add_u32 v252, 1024, v252
    s_sub_u32 s9, s9, 1
    s_cmp_lg_u32 s9, 0
    s_cbranch_scc1 L_pfl_2
L_npf_1:
    s_and_b32 s4, s2, 7
    s_and_b32 s9, s5, 3
    s_lshl_b32 s6, s4, 2
    s_add_u32 s6, s6, s9
    s_lshr_b32 s7, s5, 2
    v_lshrrev_b32 v2, 3, v1
    v_and_b32 v3, 7, v1
    v_mul_u32_u24 v4, 12288, v2
    v_lshl_add_u32 v4, v3, 4, v4
    s_cmp_lt_u32 s2, 128
    s_cbranch_scc0 L_apre
    s_cmp_ge_u32 s3, 3
    s_cselect_b32 s100, 1, 0
    s_mul_i32 s101, s100, 3
    s_sub_u32 s101, s3, s101
    s_mul_i32 s44, s7, 160
    s_mul_i32 s45, s100, 80
    s_add_u32 s44, s44, s45
    s_lshl_b32 s46, s44, 1
    s_mul_i32 s44, s44, 12288
    s_mul_i32 s45, s6, 384
    s_add_u32 s44, s44, s45
    s_lshl_b32 s45, s101, 7
    s_add_u32 s44, s44, s45
    s_mov_b32 s26, 7864320
    s_mov_b32 s27, 0x00020000
    s_waitcnt lgkmcnt(0)
    s_mov_b64 s[24:25], s[80:81]
    s_cmp_ge_u32 s3, 6
    s_cbranch_scc1 L_bnl_3
    buffer_load_dwordx4 v[20:23], v4, s[24:27], s44 offen
    s_add_u32 s44, s44, 98304
    buffer_load_dwordx4 v[24:27], v4, s[24:27], s44 offen
    s_add_u32 s44, s44, 98304
    buffer_load_dwordx4 v[28:31], v4, s[24:27], s44 offen
    s_add_u32 s44, s44, 98304
    buffer_load_dwordx4 v[32:35], v4, s[24:27], s44 offen
    s_add_u32 s44, s44, 98304
    buffer_load_dwordx4 v[36:39], v4, s[24:27], s44 offen
    s_add_u32 s44, s44, 98304
    buffer_load_dwordx4 v[40:43], v4, s[24:27], s44 offen
    s_add_u32 s44, s44, 98304
    buffer_load_dwordx4 v[44:47], v4, s[24:27], s44 offen
    s_add_u32 s44, s44, 98304
    buffer_load_dwordx4 v[48:51], v4, s[24:27], s44 offen
    s_add_u32 s44, s44, 98304
    buffer_load_dwordx4 v[52:55], v4, s[24:27], s44 offen
    s_add_u32 s44, s44, 98304
    buffer_load_dwordx4 v[56:59], v4, s[24:27], s44 offen
L_bnl_3:
    s_branch L_pre2
L_apre:
    s_lshr_b32 s100, s3, 1
    s_and_b32 s101, s3, 1
    s_mul_i32 s44, s7, 192
    s_mul_i32 s45, s100, 48
    s_add_u32 s44, s44, s45
    s_lshl_b32 s45, s101, 3
    s_add_u32 s44, s44, s45
    s_mul_i32 s44, s44, 12288
    s_mul_i32 s45, s6, 384
    s_add_u32 s44, s44, s45
    s_mov_b32 s30, 9437184
    s_mov_b32 s31, 0x00020000
    s_waitcnt lgkmcnt(0)
    s_mov_b64 s[28:29], s[82:83]
    buffer_load_dwordx4 v[20:23], v4, s[28:31], s44 offen offset:0
    buffer_load_dwordx4 v[24:27], v4, s[28:31], s44 offen offset:128
    buffer_load_dwordx4 v[28:31], v4, s[28:31], s44 offen offset:256
    s_add_u32 s44, s44, 196608
    buffer_load_dwordx4 v[32:35], v4, s[28:31], s44 offen offset:0
    buffer_load_dwordx4 v[36:39], v4, s[28:31], s44 offen offset:128
    buffer_load_dwordx4 v[40:43], v4, s[28:31], s44 offen offset:256
    s_add_u32 s44, s44, 196608
    buffer_load_dwordx4 v[44:47], v4, s[28:31], s44 offen offset:0
    buffer_load_dwordx4 v[48:51], v4, s[28:31], s44 offen offset:128
    buffer_load_dwordx4 v[52:55], v4, s[28:31], s44 offen offset:256
L_pre2:
    s_load_dword s8, s[64:65], 0
    s_mov_b32 s74, s100
    s_mov_b32 s75, s101
    s_mov_b32 s15, s46
    s_mov_b64 s[16:17], s[76:77]
    s_mov_b32 s18, 1280
    s_mov_b32 s19, 0x00020000
    s_mov_b64 s[20:21], s[78:79]
    s_mov_b32 s22, 12582912
    s_mov_b32 s23, 0x00020000
    s_mov_b64 s[24:25], s[80:81]
    s_mov_b32 s26, 7864320
    s_mov_b32 s27, 0x00020000
    s_mov_b64 s[28:29], s[82:83]
    s_mov_b32 s30, 9437184
    s_mov_b32 s31, 0x00020000
    s_mov_b64 s[32:33], s[84:85]
    s_mov_b32 s34, 9437184
    s_mov_b32 s35, 0x00020000
    s_mov_b64 s[36:37], s[86:87]
    s_mov_b32 s38, 7864320
    s_mov_b32 s39, 0x00020000
    s_mov_b64 s[44:45], s[90:91]
    s_mov_b32 s46, 1966080
    s_mov_b32 s47, 0x00020000
    s_mov_b64 s[48:49], s[92:93]
    s_mov_b32 s50, 1966080
    s_mov_b32 s51, 0x00020000
    s_mov_b64 s[52:53], s[94:95]
    s_mov_b32 s54, 1966080
    s_mov_b32 s55, 0x00020000
    s_mov_b64 s[56:57], s[96:97]
    s_mov_b32 s58, 1280
    s_mov_b32 s59, 0x00020000
    s_mov_b64 s[60:61], s[98:99]
    s_mov_b32 s62, 1280
    s_mov_b32 s63, 0x00020000
    s_mov_b32 s66, 4718592
    s_mov_b32 s67, 0x00020000
    s_mov_b32 s72, 0xff00ff00
    s_mov_b32 s73, 0xff00ff00
    s_mov_b32 s14, 1024
    s_cmp_lt_u32 s2, 128
    s_cbranch_scc0 L_aset
    v_mov_b32 v5, 2048
    v_mov_b32 v6, 0
    v_mov_b32 v7, 0
    v_mov_b32 v8, 0
    v_mov_b32 v9, 0
    ds_write_b128 v5, v[6:9]
    ds_write_b128 v5, v[6:9] offset:16
    ds_write_b128 v5, v[6:9] offset:32
    ds_write_b128 v5, v[6:9] offset:48
    ds_write_b128 v5, v[6:9] offset:64
    v_lshlrev_b32 v5, 1, v2
    v_add_u32 v9, s15, v5
    s_cmp_lg_u32 s3, 6
    s_cbranch_scc1 L_nox_4
    v_lshlrev_b32 v8, 4, v1
    buffer_load_dwordx4 v[20:23], v8, s[16:19], 0 offen
    buffer_load_dwordx4 v[24:27], v8, s[16:19], 0 offen offset:1024
L_nox_4:
    s_mov_b32 s10, s5
    s_lshl_b32 s11, s4, 5
    s_lshl_b32 s9, s10, 1
    s_add_u32 s11, s11, s9
    s_lshl_b32 s12, s4, 1
    s_lshr_b32 s9, s10, 3
    s_add_u32 s12, s12, s9
    s_and_b32 s13, s10, 7
    v_add_u32 v5, 0, v1
    v_mul_u32_u24 v6, 5462, v5
    v_lshrrev_b32 v6, 16, v6
    v_mul_u32_u24 v7, 12, v6
    v_sub_u32 v7, v5, v7
    v_mul_u32_u24 v6, 1536, v6
    v_lshl_add_u32 v212, v7, 4, v6
    v_add_u32 v5, 64, v1
    v_mul_u32_u24 v6, 5462, v5
    v_lshrrev_b32 v6, 16, v6
    v_mul_u32_u24 v7, 12, v6
    v_sub_u32 v7, v5, v7
    v_mul_u32_u24 v6, 1536, v6
    v_lshl_add_u32 v213, v7, 4, v6
    v_add_u32 v5, 128, v1
    v_mul_u32_u24 v6, 5462, v5
    v_lshrrev_b32 v6, 16, v6
    v_mul_u32_u24 v7, 12, v6
    v_sub_u32 v7, v5, v7
    v_mul_u32_u24 v6, 1536, v6
    v_lshl_add_u32 v214, v7, 4, v6
    v_mov_b32 v216, 0
    v_mov_b32 v219, v1
    v_cmp_le_u32 vcc, 32, v1
    v_add_u32 v5, 64, v1
    v_subrev_u32 v6, 32, v1
    v_cndmask_b32 v217, 0, 1, vcc
    v_cndmask_b32 v220, v5, v6, vcc
    v_mov_b32 v218, 1
    v_add_u32 v221, 32, v1
    v_mul_u32_u24 v222, 1536, v216
    v_mul_u32_u24 v223, 1536, v217
    v_mul_u32_u24 v224, 1536, v218
    s_and_b32 s84, s3, 1
    s_lshl_b32 s84, s84, 3
    s_add_u32 s86, s84, 0
    v_add_u32 v5, s86, v216
    v_xor_b32 v5, v5, v219
    v_lshl_add_u32 v226, v5, 4, v222
    s_add_u32 s86, s84, 0
    v_add_u32 v5, s86, v217
    v_xor_b32 v5, v5, v220
    v_lshl_add_u32 v227, v5, 4, v223
    s_add_u32 s86, s84, 0
    v_add_u32 v5, s86, v218
    v_xor_b32 v5, v5, v221
    v_lshl_add_u32 v228, v5, 4, v224
    s_add_u32 s86, s84, 2
    v_add_u32 v5, s86, v216
    v_xor_b32 v5, v5, v219
    v_lshl_add_u32 v229, v5, 4, v222
    s_add_u32 s86, s84, 2
    v_add_u32 v5, s86, v217
    v_xor_b32 v5, v5, v220
    v_lshl_add_u32 v230, v5, 4, v223
    s_add_u32 s86, s84, 2
    v_add_u32 v5, s86, v218
    v_xor_b32 v5, v5, v221
    v_lshl_add_u32 v231, v5, 4, v224
    s_add_u32 s86, s84, 4
    v_add_u32 v5, s86, v216
    v_xor_b32 v5, v5, v219
    v_lshl_add_u32 v232, v5, 4, v222
    s_add_u32 s86, s84, 4
    v_add_u32 v5, s86, v217
    v_xor_b32 v5, v5, v220
    v_lshl_add_u32 v233, v5, 4, v223
    s_add_u32 s86, s84, 4
    v_add_u32 v5, s86, v218
    v_xor_b32 v5, v5, v221
    v_lshl_add_u32 v234, v5, 4, v224
    s_add_u32 s86, s84, 6
    v_add_u32 v5, s86, v216
    v_xor_b32 v5, v5, v219
    v_lshl_add_u32 v235, v5, 4, v222
    s_add_u32 s86, s84, 6
    v_add_u32 v5, s86, v217
    v_xor_b32 v5, v5, v220
    v_lshl_add_u32 v236, v5, 4, v223
    s_add_u32 s86, s84, 6
    v_add_u32 v5, s86, v218
    v_xor_b32 v5, v5, v221
    v_lshl_add_u32 v237, v5, 4, v224
    s_cmp_lg_u32 s3, 6
    s_cbranch_scc1 L_nox2_5
    s_waitcnt vmcnt(0)
    ds_write_b128 v8, v[20:23] offset:4096
    ds_write_b128 v8, v[24:27] offset:5120
L_nox2_5:
    s_waitcnt lgkmcnt(0)
    s_barrier
    s_cmp_ge_u32 s3, 6
    s_cbranch_scc1 L_p1ldr_6
    s_lshl_b32 s79, s6, 3
    s_lshl_b32 s80, s7, 1
    s_add_u32 s79, s79, s80
    s_add_u32 s79, s79, s74
    s_mul_i32 s79, s79, 1536
    s_lshl_b32 s80, s75, 9
    s_add_u32 s79, s79, s80
    s_add_u32 s80, s79, 131072
    s_add_u32 s79, s79, 524288
    v_lshlrev_b32 v5, 6, v3
    v_lshl_add_u32 v5, v2, 3, v5
    v_mov_b32 v60, 0
    v_mov_b32 v61, 0
    v_mov_b32 v62, 0
    v_mov_b32 v63, 0
    v_mov_b32 v64, 0
    v_mov_b32 v65, 0
    v_mov_b32 v66, 0
    v_mov_b32 v67, 0
    ds_read_u16 v10, v9 offset:4096
    ds_read_u16 v11, v9 offset:4112
    ds_read_u16 v12, v9 offset:4128
    ds_read_u16 v13, v9 offset:4144
    ds_read_u16 v14, v9 offset:4160
    ds_read_u16 v15, v9 offset:4176
    ds_read_u16 v16, v9 offset:4192
    ds_read_u16 v17, v9 offset:4208
    ds_read_u16 v18, v9 offset:4224
    ds_read_u16 v19, v9 offset:4240
    s_waitcnt lgkmcnt(0)
    s_add_u32 s8, s8, 1
    s_waitcnt vmcnt(9)
    v_lshlrev_b32 v68, 16, v10
    v_dot2c_f32_bf16 v60, v20, v10
    v_dot2c_f32_bf16 v62, v21, v10
    v_dot2c_f32_bf16 v64, v22, v10
    v_dot2c_f32_bf16 v66, v23, v10
    v_dot2c_f32_bf16 v61, v20, v68
    v_dot2c_f32_bf16 v63, v21, v68
    v_dot2c_f32_bf16 v65, v22, v68
    v_dot2c_f32_bf16 v67, v23, v68
    s_waitcnt vmcnt(8)
    v_lshlrev_b32 v68, 16, v11
    v_dot2c_f32_bf16 v60, v24, v11
    v_dot2c_f32_bf16 v62, v25, v11
    v_dot2c_f32_bf16 v64, v26, v11
    v_dot2c_f32_bf16 v66, v27, v11
    v_dot2c_f32_bf16 v61, v24, v68
    v_dot2c_f32_bf16 v63, v25, v68
    v_dot2c_f32_bf16 v65, v26, v68
    v_dot2c_f32_bf16 v67, v27, v68
    s_waitcnt vmcnt(7)
    v_lshlrev_b32 v68, 16, v12
    v_dot2c_f32_bf16 v60, v28, v12
    v_dot2c_f32_bf16 v62, v29, v12
    v_dot2c_f32_bf16 v64, v30, v12
    v_dot2c_f32_bf16 v66, v31, v12
    v_dot2c_f32_bf16 v61, v28, v68
    v_dot2c_f32_bf16 v63, v29, v68
    v_dot2c_f32_bf16 v65, v30, v68
    v_dot2c_f32_bf16 v67, v31, v68
    s_waitcnt vmcnt(6)
    v_lshlrev_b32 v68, 16, v13
    v_dot2c_f32_bf16 v60, v32, v13
    v_dot2c_f32_bf16 v62, v33, v13
    v_dot2c_f32_bf16 v64, v34, v13
    v_dot2c_f32_bf16 v66, v35, v13
    v_dot2c_f32_bf16 v61, v32, v68
    v_dot2c_f32_bf16 v63, v33, v68
    v_dot2c_f32_bf16 v65, v34, v68
    v_dot2c_f32_bf16 v67, v35, v68
    s_waitcnt vmcnt(5)
    v_lshlrev_b32 v68, 16, v14
    v_dot2c_f32_bf16 v60, v36, v14
    v_dot2c_f32_bf16 v62, v37, v14
    v_dot2c_f32_bf16 v64, v38, v14
    v_dot2c_f32_bf16 v66, v39, v14
    v_dot2c_f32_bf16 v61, v36, v68
    v_dot2c_f32_bf16 v63, v37, v68
    v_dot2c_f32_bf16 v65, v38, v68
    v_dot2c_f32_bf16 v67, v39, v68
    s_waitcnt vmcnt(4)
    v_lshlrev_b32 v68, 16, v15
    v_dot2c_f32_bf16 v60, v40, v15
    v_dot2c_f32_bf16 v62, v41, v15
    v_dot2c_f32_bf16 v64, v42, v15
    v_dot2c_f32_bf16 v66, v43, v15
    v_dot2c_f32_bf16 v61, v40, v68
    v_dot2c_f32_bf16 v63, v41, v68
    v_dot2c_f32_bf16 v65, v42, v68
    v_dot2c_f32_bf16 v67, v43, v68
    s_waitcnt vmcnt(3)
    v_lshlrev_b32 v68, 16, v16
    v_dot2c_f32_bf16 v60, v44, v16
    v_dot2c_f32_bf16 v62, v45, v16
    v_dot2c_f32_bf16 v64, v46, v16
    v_dot2c_f32_bf16 v66, v47, v16
    v_dot2c_f32_bf16 v61, v44, v68
    v_dot2c_f32_bf16 v63, v45, v68
    v_dot2c_f32_bf16 v65, v46, v68
    v_dot2c_f32_bf16 v67, v47, v68
    s_waitcnt vmcnt(2)
    v_lshlrev_b32 v68, 16, v17
    v_dot2c_f32_bf16 v60, v48, v17
    v_dot2c_f32_bf16 v62, v49, v17
    v_dot2c_f32_bf16 v64, v50, v17
    v_dot2c_f32_bf16 v66, v51, v17
    v_dot2c_f32_bf16 v61, v48, v68
    v_dot2c_f32_bf16 v63, v49, v68
    v_dot2c_f32_bf16 v65, v50, v68
    v_dot2c_f32_bf16 v67, v51, v68
    s_waitcnt vmcnt(1)
    v_lshlrev_b32 v68, 16, v18
    v_dot2c_f32_bf16 v60, v52, v18
    v_dot2c_f32_bf16 v62, v53, v18
    v_dot2c_f32_bf16 v64, v54, v18
    v_dot2c_f32_bf16 v66, v55, v18
    v_dot2c_f32_bf16 v61, v52, v68
    v_dot2c_f32_bf16 v63, v53, v68
    v_dot2c_f32_bf16 v65, v54, v68
    v_dot2c_f32_bf16 v67, v55, v68
    s_waitcnt vmcnt(0)
    v_lshlrev_b32 v68, 16, v19
    v_dot2c_f32_bf16 v60, v56, v19
    v_dot2c_f32_bf16 v62, v57, v19
    v_dot2c_f32_bf16 v64, v58, v19
    v_dot2c_f32_bf16 v66, v59, v19
    v_dot2c_f32_bf16 v61, v56, v68
    v_dot2c_f32_bf16 v63, v57, v68
    v_dot2c_f32_bf16 v65, v58, v68
    v_dot2c_f32_bf16 v67, v59, v68
    s_nop 2
    v_permlane32_swap_b32 v60, v64
    v_permlane32_swap_b32 v61, v65
    v_permlane32_swap_b32 v62, v66
    v_permlane32_swap_b32 v63, v67
    s_nop 1
    v_add_f32 v60, v60, v64
    v_add_f32 v61, v61, v65
    v_add_f32 v62, v62, v66
    v_add_f32 v63, v63, v67
    s_nop 1
    v_permlane16_swap_b32 v60, v62
    v_permlane16_swap_b32 v61, v63
    s_nop 1
    v_add_f32 v60, v60, v62
    v_add_f32 v61, v61, v63
    s_nop 0
    v_cndmask_b32 v68, v60, v61, s[72:73]
    v_cndmask_b32 v69, v61, v60, s[72:73]
    s_nop 1
    v_add_f32_dpp v60, v69, v68 row_ror:8 row_mask:0xf bank_mask:0xf
    v_mov_b32 v61, s8
    buffer_store_dwordx2 v[60:61], v5, s[64:67], s79 offen
    buffer_store_dwordx2 v[60:61], v5, s[64:67], s80 offen sc1
    s_branch L_p1j_7
L_p1ldr_6:
    v_subrev_u32 v5, 384, v0
    v_mov_b32 v76, -1
    v_mov_b32 v77, -1
    v_mov_b32 v78, -1
    v_mov_b32 v79, -1
    v_lshlrev_b32 v6, 4, v5
    v_mov_b32 v7, 0x7fffffff
    v_cmp_gt_u32 vcc, 64, v5
    s_mul_i32 s84, s11, 2560
    s_nop 0
    v_cndmask_b32 v8, v7, v6, vcc
    s_add_u32 s85, s84, 1048576
    buffer_store_dwordx4 v[76:79], v6, s[64:67], s85 offen sc1
    buffer_store_dwordx4 v[76:79], v6, s[64:67], s85 offen offset:2048 sc1
    s_add_u32 s85, s85, 4096
    buffer_store_dwordx4 v[76:79], v8, s[64:67], s85 offen sc1
    s_add_u32 s85, s84, 1703936
    buffer_store_dwordx4 v[76:79], v6, s[64:67], s85 offen sc1
    buffer_store_dwordx4 v[76:79], v6, s[64:67], s85 offen offset:2048 sc1
    s_add_u32 s85, s85, 4096
    buffer_store_dwordx4 v[76:79], v8, s[64:67], s85 offen sc1
    s_lshl_b32 s87, s13, 4
    s_add_u32 s87, s87, s12
    s_mul_i32 s87, s87, 384
    s_add_u32 s87, s87, 2752512
    s_mov_b32 s88, 49152
    v_add_u32 v8, 0, v5
    v_mul_u32_u24 v9, 2731, v8
    v_lshrrev_b32 v9, 16, v9
    v_mul_u32_u24 v70, 24, v9
    v_sub_u32 v70, v8, v70
    v_mul_lo_u32 v9, v9, s88
    v_lshl_add_u32 v9, v70, 4, v9
    buffer_store_dwordx4 v[76:79], v9, s[64:67], s87 offen sc1
    v_add_u32 v8, 128, v5
    v_mul_u32_u24 v9, 2731, v8
    v_lshrrev_b32 v9, 16, v9
    v_mul_u32_u24 v70, 24, v9
    v_sub_u32 v70, v8, v70
    v_mul_lo_u32 v9, v9, s88
    v_lshl_add_u32 v9, v70, 4, v9
    buffer_store_dwordx4 v[76:79], v9, s[64:67], s87 offen sc1
    v_add_u32 v8, 256, v5
    v_mul_u32_u24 v9, 2731, v8
    v_lshrrev_b32 v9, 16, v9
    v_mul_u32_u24 v70, 24, v9
    v_sub_u32 v70, v8, v70
    v_mul_lo_u32 v9, v9, s88
    v_lshl_add_u32 v9, v70, 4, v9
    buffer_store_dwordx4 v[76:79], v9, s[64:67], s87 offen sc1
    v_add_u32 v8, 384, v5
    v_mul_u32_u24 v9, 2731, v8
    v_lshrrev_b32 v9, 16, v9
    v_mul_u32_u24 v70, 24, v9
    v_sub_u32 v70, v8, v70
    v_mul_lo_u32 v9, v9, s88
    v_lshl_add_u32 v9, v70, 4, v9
    buffer_store_dwordx4 v[76:79], v9, s[64:67], s87 offen sc1
    v_add_u32 v8, 512, v5
    v_mul_u32_u24 v9, 2731, v8
    v_lshrrev_b32 v9, 16, v9
    v_mul_u32_u24 v70, 24, v9
    v_sub_u32 v70, v8, v70
    v_mul_lo_u32 v9, v9, s88
    v_lshl_add_u32 v9, v70, 4, v9
    buffer_store_dwordx4 v[76:79], v9, s[64:67], s87 offen sc1
    v_add_u32 v8, 640, v5
    v_mul_u32_u24 v9, 2731, v8
    v_lshrrev_b32 v9, 16, v9
    v_mul_u32_u24 v70, 24, v9
    v_sub_u32 v70, v8, v70
    v_mul_lo_u32 v9, v9, s88
    v_lshl_add_u32 v9, v70, 4, v9
    buffer_store_dwordx4 v[76:79], v9, s[64:67], s87 offen sc1
    v_lshlrev_b32 v8, 7, v5
    v_cmp_gt_u32 vcc, 32, v5
    s_lshl_b32 s87, s12, 3
    s_add_u32 s87, s87, 2359296
    v_cndmask_b32 v8, v7, v8, vcc
    s_cmp_eq_u32 s13, 0
    s_cselect_b32 s87, s87, 0x7fffff00
    buffer_store_dwordx2 v[76:77], v8, s[64:67], s87 offen sc1
    s_waitcnt lgkmcnt(0)
    s_add_u32 s8, s8, 1
L_p1j_7:
    s_barrier
    s_lshl_b32 s82, s4, 10
    s_lshl_b32 s83, s10, 6
    s_add_u32 s82, s82, s83
    s_lshl_b32 s83, s3, 3
    s_add_u32 s82, s82, s83
    s_mul_i32 s82, s82, 1536
    s_mul_i32 s85, s3, 12288
    s_add_u32 s85, s85, 8192
    s_add_u32 m0, s85, 0
    s_nop 0
    buffer_load_dwordx4 v226, s[20:23], s82 offen lds
    s_add_u32 m0, s85, 1024
    s_nop 0
    buffer_load_dwordx4 v227, s[20:23], s82 offen lds
    s_add_u32 m0, s85, 2048
    s_nop 0
    buffer_load_dwordx4 v228, s[20:23], s82 offen lds
    s_add_u32 m0, s85, 3072
    s_add_u32 s82, s82, 3072
    buffer_load_dwordx4 v229, s[20:23], s82 offen lds
    s_add_u32 m0, s85, 4096
    s_nop 0
    buffer_load_dwordx4 v230, s[20:23], s82 offen lds
    s_add_u32 m0, s85, 5120
    s_nop 0
    buffer_load_dwordx4 v231, s[20:23], s82 offen lds
    s_add_u32 m0, s85, 6144
    s_add_u32 s82, s82, 3072
    buffer_load_dwordx4 v232, s[20:23], s82 offen lds
    s_add_u32 m0, s85, 7168
    s_nop 0
    buffer_load_dwordx4 v233, s[20:23], s82 offen lds
    s_add_u32 m0, s85, 8192
    s_nop 0
    buffer_load_dwordx4 v234, s[20:23], s82 offen lds
    s_add_u32 m0, s85, 9216
    s_add_u32 s82, s82, 3072
    buffer_load_dwordx4 v235, s[20:23], s82 offen lds
    s_add_u32 m0, s85, 10240
    s_nop 0
    buffer_load_dwordx4 v236, s[20:23], s82 offen lds
    s_add_u32 m0, s85, 11264
    s_nop 0
    buffer_load_dwordx4 v237, s[20:23], s82 offen lds
    s_cmp_lt_u32 s3, 6
    s_cbranch_scc1 L_nocf_8
    s_waitcnt vmcnt(12)
    s_lshl_b32 s87, s2, 1
    s_add_u32 s87, s87, s3
    s_lshl_b32 s87, s87, 2
    s_add_u32 s87, s87, 1000
    v_mov_b32 v5, s8
    v_mov_b32 v6, 0
    s_mov_b64 exec, 1
    buffer_store_dword v5, v6, s[64:67], s87 offen sc1
    s_mov_b64 exec, -1
L_nocf_8:
    s_branch L_bs
L_aset:
    s_lshl_b32 s84, s4, 4
    s_add_u32 s84, s84, s5
    s_mul_i32 s84, s84, 2560
    s_add_u32 s84, s84, 2424832
    v_mov_b32 v76, -1
    v_mov_b32 v77, -1
    v_mov_b32 v78, -1
    v_mov_b32 v79, -1
    v_lshlrev_b32 v80, 4, v0
    v_mov_b32 v81, 0x7fffffff
    v_cmp_gt_u32 vcc, 160, v0
    s_nop 1
    v_cndmask_b32 v80, v81, v80, vcc
    buffer_store_dwordx4 v[76:79], v80, s[64:67], s84 offen sc1
    v_lshlrev_b32 v5, 2, v1
    v_mov_b32 v6, 0
    ds_write_b32 v5, v6 offset:14336
    ds_write_b32 v5, v6 offset:14592
    s_mul_i32 s79, s6, 12288
    s_add_u32 s80, s79, 524288
    s_add_u32 s79, s79, 131072
    s_waitcnt vmcnt(0) lgkmcnt(0)
    s_add_u32 s8, s8, 1
    s_cmp_ge_u32 s3, 3
    s_cbranch_scc1 L_e1skip_9
    v_lshlrev_b32 v5, 3, v0
    s_mov_b32 s96, 0
L_poll_10:
    s_and_b32 s9, s96, 7
    s_cmp_eq_u32 s9, 7
    s_cselect_b32 s97, s79, s80
    buffer_load_dwordx2 v[84:85], v5, s[64:67], s97 offen offset:0 sc1
    buffer_load_dwordx2 v[86:87], v5, s[64:67], s97 offen offset:1536 sc1
    s_add_u32 s97, s97, 3072
    buffer_load_dwordx2 v[88:89], v5, s[64:67], s97 offen offset:0 sc1
    buffer_load_dwordx2 v[90:91], v5, s[64:67], s97 offen offset:1536 sc1
    s_add_u32 s97, s97, 3072
    buffer_load_dwordx2 v[92:93], v5, s[64:67], s97 offen offset:0 sc1
    buffer_load_dwordx2 v[94:95], v5, s[64:67], s97 offen offset:1536 sc1
    s_add_u32 s97, s97, 3072
    buffer_load_dwordx2 v[96:97], v5, s[64:67], s97 offen offset:0 sc1
    buffer_load_dwordx2 v[98:99], v5, s[64:67], s97 offen offset:1536 sc1
    s_waitcnt vmcnt(0)
    v_xor_b32 v6, s8, v85
    v_xor_b32 v7, s8, v87
    v_or_b32 v6, v6, v7
    v_xor_b32 v7, s8, v89
    v_or_b32 v6, v6, v7
    v_xor_b32 v7, s8, v91
    v_or_b32 v6, v6, v7
    v_xor_b32 v7, s8, v93
    v_or_b32 v6, v6, v7
    v_xor_b32 v7, s8, v95
    v_or_b32 v6, v6, v7
    v_xor_b32 v7, s8, v97
    v_or_b32 v6, v6, v7
    v_xor_b32 v7, s8, v99
    v_or_b32 v6, v6, v7
    v_cmp_ne_u32 vcc, 0, v6
    s_cbranch_vccz L_ok_11
    s_add_u32 s96, s96, 1
    s_cmp_lt_u32 s96, 100000
    s_cbranch_scc1 L_poll_10
L_ok_11:
    v_add_f32 v84, v84, v86
    v_add_f32 v84, v84, v88
    v_add_f32 v84, v84, v90
    v_add_f32 v84, v84, v92
    v_add_f32 v84, v84, v94
    v_add_f32 v84, v84, v96
    v_add_f32 v84, v84, v98
    v_cvt_pk_bf16_f32 v6, v84, v84
    v_lshlrev_b32 v7, 1, v0
    ds_write_b16 v7, v6 offset:0
    s_waitcnt lgkmcnt(0)
L_e1skip_9:
    v_lshlrev_b32 v5, 4, v3
    s_lshl_b32 s81, s3, 6
    v_lshlrev_b32 v10, 1, v2
    v_add_u32 v10, s81, v10
    v_lshlrev_b32 v6, 4, v1
    v_mov_b32 v7, 4
    v_cmp_eq_u32 vcc, 3, v1
    v_mov_b32 v8, 12
    v_mov_b32 v9, 16
    v_cndmask_b32 v6, v6, v8, vcc
    v_cndmask_b32 v7, v7, v9, vcc
    v_and_b32 v6, 63, v6
    v_add_u32 v11, s81, v6
    v_add_u32 v12, v11, v7
    v_add_u32 v13, v12, v7
    s_lshl_b32 s82, s7, 2
    s_add_u32 s82, s82, s74
    s_lshl_b32 s82, s82, 12
    s_lshl_b32 s83, s75, 9
    s_add_u32 s82, s82, s83
    s_lshl_b32 s83, s6, 4
    s_add_u32 s82, s82, s83
    s_add_u32 s82, s82, 65536
    v_lshlrev_b32 v14, 10, v1
    v_mov_b32 v7, 0x7fffffff
    v_cmp_gt_u32 vcc, 4, v1
    v_mov_b32 v75, s8
    s_nop 0
    v_cndmask_b32 v14, v7, v14, vcc
    v_mov_b32 v68, 0
    v_mov_b32 v69, 0
    v_mov_b32 v70, 0
    s_barrier
    ds_read_b128 v[56:59], v5 offset:0
    ds_read_b128 v[60:63], v5 offset:128
    ds_read_b128 v[64:67], v5 offset:256
    s_waitcnt lgkmcnt(2)
    v_dot2c_f32_bf16 v68, v20, v56
    v_dot2c_f32_bf16 v69, v32, v56
    v_dot2c_f32_bf16 v70, v44, v56
    v_dot2c_f32_bf16 v68, v21, v57
    v_dot2c_f32_bf16 v69, v33, v57
    v_dot2c_f32_bf16 v70, v45, v57
    v_dot2c_f32_bf16 v68, v22, v58
    v_dot2c_f32_bf16 v69, v34, v58
    v_dot2c_f32_bf16 v70, v46, v58
    v_dot2c_f32_bf16 v68, v23, v59
    v_dot2c_f32_bf16 v69, v35, v59
    v_dot2c_f32_bf16 v70, v47, v59
    s_waitcnt lgkmcnt(1)
    v_dot2c_f32_bf16 v68, v24, v60
    v_dot2c_f32_bf16 v69, v36, v60
    v_dot2c_f32_bf16 v70, v48, v60
    v_dot2c_f32_bf16 v68, v25, v61
    v_dot2c_f32_bf16 v69, v37, v61
    v_dot2c_f32_bf16 v70, v49, v61
    v_dot2c_f32_bf16 v68, v26, v62
    v_dot2c_f32_bf16 v69, v38, v62
    v_dot2c_f32_bf16 v70, v50, v62
    v_dot2c_f32_bf16 v68, v27, v63
    v_dot2c_f32_bf16 v69, v39, v63
    v_dot2c_f32_bf16 v70, v51, v63
    s_waitcnt lgkmcnt(0)
    v_dot2c_f32_bf16 v68, v28, v64
    v_dot2c_f32_bf16 v69, v40, v64
    v_dot2c_f32_bf16 v70, v52, v64
    v_dot2c_f32_bf16 v68, v29, v65
    v_dot2c_f32_bf16 v69, v41, v65
    v_dot2c_f32_bf16 v70, v53, v65
    v_dot2c_f32_bf16 v68, v30, v66
    v_dot2c_f32_bf16 v69, v42, v66
    v_dot2c_f32_bf16 v70, v54, v66
    v_dot2c_f32_bf16 v68, v31, v67
    v_dot2c_f32_bf16 v69, v43, v67
    v_dot2c_f32_bf16 v70, v55, v67
    s_nop 2
    v_add_f32_dpp v68, v68, v68 quad_perm:[1,0,3,2] row_mask:0xf bank_mask:0xf
    v_add_f32_dpp v69, v69, v69 quad_perm:[1,0,3,2] row_mask:0xf bank_mask:0xf
    v_add_f32_dpp v70, v70, v70 quad_perm:[1,0,3,2] row_mask:0xf bank_mask:0xf
    v_add_f32_dpp v68, v68, v68 quad_perm:[2,3,0,1] row_mask:0xf bank_mask:0xf
    v_add_f32_dpp v69, v69, v69 quad_perm:[2,3,0,1] row_mask:0xf bank_mask:0xf
    v_add_f32_dpp v70, v70, v70 quad_perm:[2,3,0,1] row_mask:0xf bank_mask:0xf
    v_add_f32_dpp v68, v68, v68 row_half_mirror row_mask:0xf bank_mask:0xf
    v_add_f32_dpp v69, v69, v69 row_half_mirror row_mask:0xf bank_mask:0xf
    v_add_f32_dpp v70, v70, v70 row_half_mirror row_mask:0xf bank_mask:0xf
    v_cvt_pk_bf16_f32 v68, v68, v68
    v_cvt_pk_bf16_f32 v69, v69, v69
    v_cvt_pk_bf16_f32 v70, v70, v70
    ds_write_b16 v10, v68 offset:512
    ds_write_b16 v10, v69 offset:528
    ds_write_b16 v10, v70 offset:544
    s_waitcnt lgkmcnt(0)
    ds_read_b32 v72, v11 offset:512
    ds_read_b32 v73, v12 offset:512
    ds_read_b32 v74, v13 offset:512
    s_waitcnt lgkmcnt(0)
    buffer_store_dwordx4 v[72:75], v14, s[64:67], s82 offen sc1
    s_barrier
    s_branch L_aback
L_bs:
    v_and_b32 v6, 31, v1
    v_lshrrev_b32 v7, 5, v1
    v_and_b32 v8, 15, v6
    v_xor_b32 v8, v8, v7
    v_mul_u32_u24 v6, 1536, v6
    v_add_u32 v6, 8192, v6
    s_mul_i32 s76, s3, 24
    s_add_u32 s77, s76, 0
    v_xor_b32 v9, s77, v8
    v_lshl_add_u32 v226, v9, 4, v6
    s_add_u32 s77, s76, 2
    v_xor_b32 v9, s77, v8
    v_lshl_add_u32 v227, v9, 4, v6
    s_add_u32 s77, s76, 4
    v_xor_b32 v9, s77, v8
    v_lshl_add_u32 v228, v9, 4, v6
    s_add_u32 s77, s76, 6
    v_xor_b32 v9, s77, v8
    v_lshl_add_u32 v229, v9, 4, v6
    s_add_u32 s77, s76, 8
    v_xor_b32 v9, s77, v8
    v_lshl_add_u32 v230, v9, 4, v6
    s_add_u32 s77, s76, 10
    v_xor_b32 v9, s77, v8
    v_lshl_add_u32 v231, v9, 4, v6
    s_add_u32 s77, s76, 12
    v_xor_b32 v9, s77, v8
    v_lshl_add_u32 v232, v9, 4, v6
    s_add_u32 s77, s76, 14
    v_xor_b32 v9, s77, v8
    v_lshl_add_u32 v233, v9, 4, v6
    s_add_u32 s77, s76, 16
    v_xor_b32 v9, s77, v8
    v_lshl_add_u32 v234, v9, 4, v6
    s_add_u32 s77, s76, 18
    v_xor_b32 v9, s77, v8
    v_lshl_add_u32 v235, v9, 4, v6
    s_add_u32 s77, s76, 20
    v_xor_b32 v9, s77, v8
    v_lshl_add_u32 v236, v9, 4, v6
    s_add_u32 s77, s76, 22
    v_xor_b32 v9, s77, v8
    v_lshl_add_u32 v237, v9, 4, v6
    s_lshl_b32 s74, s3, 14
    s_add_u32 s74, s74, 65536
    v_lshlrev_b32 v5, 4, v1
    s_add_u32 s83, s74, 0
    s_add_u32 s84, s74, 4096
    s_add_u32 s85, s74, 8192
    s_add_u32 s86, s74, 12288
    s_waitcnt vmcnt(0)
    s_barrier
    s_cmp_ge_u32 s3, 4
    s_cbranch_scc1 L_notS_12
    buffer_load_dwordx4 v[20:23], v5, s[64:67], s83 offen offset:0 sc1
    buffer_load_dwordx4 v[24:27], v5, s[64:67], s83 offen offset:1024 sc1
    buffer_load_dwordx4 v[28:31], v5, s[64:67], s83 offen offset:2048 sc1
    buffer_load_dwordx4 v[32:35], v5, s[64:67], s83 offen offset:3072 sc1
    buffer_load_dwordx4 v[36:39], v5, s[64:67], s84 offen offset:0 sc1
    buffer_load_dwordx4 v[40:43], v5, s[64:67], s84 offen offset:1024 sc1
    buffer_load_dwordx4 v[44:47], v5, s[64:67], s84 offen offset:2048 sc1
    buffer_load_dwordx4 v[48:51], v5, s[64:67], s84 offen offset:3072 sc1
    buffer_load_dwordx4 v[52:55], v5, s[64:67], s85 offen offset:0 sc1
    buffer_load_dwordx4 v[56:59], v5, s[64:67], s85 offen offset:1024 sc1
    buffer_load_dwordx4 v[60:63], v5, s[64:67], s85 offen offset:2048 sc1
    buffer_load_dwordx4 v[64:67], v5, s[64:67], s85 offen offset:3072 sc1
    buffer_load_dwordx4 v[68:71], v5, s[64:67], s86 offen offset:0 sc1
    buffer_load_dwordx4 v[72:75], v5, s[64:67], s86 offen offset:1024 sc1
    buffer_load_dwordx4 v[76:79], v5, s[64:67], s86 offen offset:2048 sc1
    buffer_load_dwordx4 v[80:83], v5, s[64:67], s86 offen offset:3072 sc1
    ds_read_b128 v[84:87], v226
    ds_read_b128 v[132:135], v226 offset:49152
    ds_read_b128 v[88:91], v227
    ds_read_b128 v[136:139], v227 offset:49152
    ds_read_b128 v[92:95], v228
    ds_read_b128 v[140:143], v228 offset:49152
    ds_read_b128 v[96:99], v229
    ds_read_b128 v[144:147], v229 offset:49152
    ds_read_b128 v[100:103], v230
    ds_read_b128 v[148:151], v230 offset:49152
    ds_read_b128 v[104:107], v231
    ds_read_b128 v[152:155], v231 offset:49152
    s_waitcnt lgkmcnt(0)
    ds_read_b128 v[108:111], v232
    ds_read_b128 v[156:159], v232 offset:49152
    ds_read_b128 v[112:115], v233
    ds_read_b128 v[160:163], v233 offset:49152
    ds_read_b128 v[116:119], v234
    ds_read_b128 v[164:167], v234 offset:49152
    ds_read_b128 v[120:123], v235
    ds_read_b128 v[168:171], v235 offset:49152
    ds_read_b128 v[124:127], v236
    ds_read_b128 v[172:175], v236 offset:49152
    ds_read_b128 v[128:131], v237
    ds_read_b128 v[176:179], v237 offset:49152
    s_waitcnt lgkmcnt(0)
    s_barrier
    s_lshl_b32 s76, s3, 13
    s_add_u32 s76, s76, 57344
    v_add_u32 v10, s76, v5
    s_lshl_b32 s76, s3, 10
    s_add_u32 s76, s76, 57344
    v_add_u32 v11, s76, v5
    v_bfe_u32 v12, v1, 4, 1
    v_lshlrev_b32 v12, 10, v12
    v_and_b32 v9, 15, v1
    v_lshl_add_u32 v12, v9, 4, v12
    v_lshrrev_b32 v9, 5, v1
    v_lshl_add_u32 v12, v9, 3, v12
    v_and_b32 v13, 31, v1
    v_lshlrev_b32 v13, 2, v13
    v_mov_b32 v9, 0x7fffffff
    v_cmp_gt_u32 vcc, 32, v1
    s_mul_i32 s78, s11, 2560
    s_nop 0
    v_cndmask_b32 v13, v9, v13, vcc
    s_lshl_b32 s77, s3, 8
    s_add_u32 s79, s78, s77
    s_lshl_b32 s77, s3, 7
    s_add_u32 s80, s78, s77
    s_add_u32 s80, s80, 2048
    s_mov_b32 s15, 15
    s_mov_b32 s96, 0
    s_mov_b64 s[24:25], -1
    s_mov_b64 s[26:27], -1
    s_mov_b64 s[28:29], -1
    s_mov_b64 s[30:31], -1
    s_branch L_gpc_16
L_gp_14:
    s_bitcmp0_b32 s15, 0
    s_cbranch_scc1 L_gi_17
    s_mov_b64 exec, s[24:25]
    buffer_load_dwordx4 v[20:23], v5, s[64:67], s83 offen offset:0 sc1
    buffer_load_dwordx4 v[24:27], v5, s[64:67], s83 offen offset:1024 sc1
    buffer_load_dwordx4 v[28:31], v5, s[64:67], s83 offen offset:2048 sc1
    buffer_load_dwordx4 v[32:35], v5, s[64:67], s83 offen offset:3072 sc1
L_gi_17:
    s_bitcmp0_b32 s15, 1
    s_cbranch_scc1 L_gi_18
    s_mov_b64 exec, s[26:27]
    buffer_load_dwordx4 v[36:39], v5, s[64:67], s84 offen offset:0 sc1
    buffer_load_dwordx4 v[40:43], v5, s[64:67], s84 offen offset:1024 sc1
    buffer_load_dwordx4 v[44:47], v5, s[64:67], s84 offen offset:2048 sc1
    buffer_load_dwordx4 v[48:51], v5, s[64:67], s84 offen offset:3072 sc1
L_gi_18:
    s_bitcmp0_b32 s15, 2
    s_cbranch_scc1 L_gi_19
    s_mov_b64 exec, s[28:29]
    buffer_load_dwordx4 v[52:55], v5, s[64:67], s85 offen offset:0 sc1
    buffer_load_dwordx4 v[56:59], v5, s[64:67], s85 offen offset:1024 sc1
    buffer_load_dwordx4 v[60:63], v5, s[64:67], s85 offen offset:2048 sc1
    buffer_load_dwordx4 v[64:67], v5, s[64:67], s85 offen offset:3072 sc1
L_gi_19:
    s_bitcmp0_b32 s15, 3
    s_cbranch_scc1 L_gi_20
    s_mov_b64 exec, s[30:31]
    buffer_load_dwordx4 v[68:71], v5, s[64:67], s86 offen offset:0 sc1
    buffer_load_dwordx4 v[72:75], v5, s[64:67], s86 offen offset:1024 sc1
    buffer_load_dwordx4 v[76:79], v5, s[64:67], s86 offen offset:2048 sc1
    buffer_load_dwordx4 v[80:83], v5, s[64:67], s86 offen offset:3072 sc1
L_gi_20:
    s_mov_b64 exec, -1
L_gpc_16:
    s_waitcnt vmcnt(0)
    s_bitcmp0_b32 s15, 0
    s_cbranch_scc1 L_gc_21
    v_xor_b32 v6, s8, v23
    v_xor_b32 v7, s8, v27
    v_or_b32 v6, v6, v7
    v_xor_b32 v7, s8, v31
    v_or_b32 v6, v6, v7
    v_xor_b32 v7, s8, v35
    v_or_b32 v6, v6, v7
    v_cmp_ne_u32 vcc, 0, v6
    s_mov_b64 s[24:25], vcc
    s_cbranch_vccnz L_gc_21
    s_bitset0_b32 s15, 0
L_gc_21:
    s_bitcmp0_b32 s15, 1
    s_cbranch_scc1 L_gc_22
    v_xor_b32 v6, s8, v39
    v_xor_b32 v7, s8, v43
    v_or_b32 v6, v6, v7
    v_xor_b32 v7, s8, v47
    v_or_b32 v6, v6, v7
    v_xor_b32 v7, s8, v51
    v_or_b32 v6, v6, v7
    v_cmp_ne_u32 vcc, 0, v6
    s_mov_b64 s[26:27], vcc
    s_cbranch_vccnz L_gc_22
    s_bitset0_b32 s15, 1
L_gc_22:
    s_bitcmp0_b32 s15, 2
    s_cbranch_scc1 L_gc_23
    v_xor_b32 v6, s8, v55
    v_xor_b32 v7, s8, v59
    v_or_b32 v6, v6, v7
    v_xor_b32 v7, s8, v63
    v_or_b32 v6, v6, v7
    v_xor_b32 v7, s8, v67
    v_or_b32 v6, v6, v7
    v_cmp_ne_u32 vcc, 0, v6
    s_mov_b64 s[28:29], vcc
    s_cbranch_vccnz L_gc_23
    s_bitset0_b32 s15, 2
L_gc_23:
    s_bitcmp0_b32 s15, 3
    s_cbranch_scc1 L_gc_24
    v_xor_b32 v6, s8, v71
    v_xor_b32 v7, s8, v75
    v_or_b32 v6, v6, v7
    v_xor_b32 v7, s8, v79
    v_or_b32 v6, v6, v7
    v_xor_b32 v7, s8, v83
    v_or_b32 v6, v6, v7
    v_cmp_ne_u32 vcc, 0, v6
    s_mov_b64 s[30:31], vcc
    s_cbranch_vccnz L_gc_24
    s_bitset0_b32 s15, 3
L_gc_24:
    s_cmp_eq_u32 s15, 0
    s_cbranch_scc1 L_gpd_15
    s_add_u32 s96, s96, 1
    s_cmp_lt_u32 s96, 100000
    s_cbranch_scc1 L_gp_14
L_gpd_15:
    v_mov_b32 v23, v32
    v_mov_b32 v27, v33
    v_mov_b32 v31, v34
    v_mov_b32 v39, v48
    v_mov_b32 v43, v49
    v_mov_b32 v47, v50
    v_mov_b32 v55, v64
    v_mov_b32 v59, v65
    v_mov_b32 v63, v66
    v_mov_b32 v71, v80
    v_mov_b32 v75, v81
    v_mov_b32 v79, v82
    s_nop 0
    v_mfma_f32_32x32x16_bf16 v[180:195], v[84:87], v[20:23], 0
    v_mfma_f32_32x32x16_bf16 v[196:211], v[132:135], v[20:23], 0
    v_mfma_f32_32x32x16_bf16 v[180:195], v[88:91], v[24:27], v[180:195]
    v_mfma_f32_32x32x16_bf16 v[196:211], v[136:139], v[24:27], v[196:211]
    v_mfma_f32_32x32x16_bf16 v[180:195], v[92:95], v[28:31], v[180:195]
    v_mfma_f32_32x32x16_bf16 v[196:211], v[140:143], v[28:31], v[196:211]
    v_mfma_f32_32x32x16_bf16 v[180:195], v[96:99], v[36:39], v[180:195]
    v_mfma_f32_32x32x16_bf16 v[196:211], v[144:147], v[36:39], v[196:211]
    v_mfma_f32_32x32x16_bf16 v[180:195], v[100:103], v[40:43], v[180:195]
    v_mfma_f32_32x32x16_bf16 v[196:211], v[148:151], v[40:43], v[196:211]
    v_mfma_f32_32x32x16_bf16 v[180:195], v[104:107], v[44:47], v[180:195]
    v_mfma_f32_32x32x16_bf16 v[196:211], v[152:155], v[44:47], v[196:211]
    v_mfma_f32_32x32x16_bf16 v[180:195], v[108:111], v[52:55], v[180:195]
    v_mfma_f32_32x32x16_bf16 v[196:211], v[156:159], v[52:55], v[196:211]
    v_mfma_f32_32x32x16_bf16 v[180:195], v[112:115], v[56:59], v[180:195]
    v_mfma_f32_32x32x16_bf16 v[196:211], v[160:163], v[56:59], v[196:211]
    v_mfma_f32_32x32x16_bf16 v[180:195], v[116:119], v[60:63], v[180:195]
    v_mfma_f32_32x32x16_bf16 v[196:211], v[164:167], v[60:63], v[196:211]
    v_mfma_f32_32x32x16_bf16 v[180:195], v[120:123], v[68:71], v[180:195]
    v_mfma_f32_32x32x16_bf16 v[196:211], v[168:171], v[68:71], v[196:211]
    v_mfma_f32_32x32x16_bf16 v[180:195], v[124:127], v[72:75], v[180:195]
    v_mfma_f32_32x32x16_bf16 v[196:211], v[172:175], v[72:75], v[196:211]
    v_mfma_f32_32x32x16_bf16 v[180:195], v[128:131], v[76:79], v[180:195]
    v_mfma_f32_32x32x16_bf16 v[196:211], v[176:179], v[76:79], v[196:211]
    s_nop 3
    s_nop 7
    ds_write_b128 v10, v[180:183] offset:0
    ds_write_b128 v10, v[184:187] offset:1024
    ds_write_b128 v10, v[188:191] offset:2048
    ds_write_b128 v10, v[192:195] offset:3072
    s_nop 3
    ds_write_b128 v10, v[196:199] offset:4096
    ds_write_b128 v10, v[200:203] offset:5120
    ds_write_b128 v10, v[204:207] offset:6144
    ds_write_b128 v10, v[208:211] offset:7168
    s_waitcnt lgkmcnt(0)
    s_and_b32 s9, s3, 3
    s_lshl_b32 s9, s9, 2
    s_add_u32 s9, s9, 2064
    v_mov_b32 v6, s9
    v_mov_b32 v7, 1
    ds_write_b32 v6, v7
    v_mov_b32 v6, 2064
    s_mov_b32 s96, 0
L_poll_25:
    ds_read_b128 v[20:23], v6
    s_waitcnt lgkmcnt(0)
    v_and_b32 v20, v20, v21
    v_and_b32 v22, v22, v23
    v_and_b32 v20, v20, v22
    v_xor_b32 v20, 1, v20
    v_cmp_ne_u32 vcc, 0, v20
    s_cbranch_vccz L_ok_26
    s_add_u32 s96, s96, 1
    s_cmp_lt_u32 s96, 100000
    s_cbranch_scc1 L_poll_25
L_ok_26:
    ds_read_b128 v[20:23], v11 offset:0
    ds_read_b128 v[24:27], v11 offset:4096
    ds_read_b128 v[28:31], v11 offset:8192
    ds_read_b128 v[32:35], v11 offset:12288
    ds_read_b128 v[36:39], v11 offset:16384
    ds_read_b128 v[40:43], v11 offset:20480
    ds_read_b128 v[44:47], v11 offset:24576
    ds_read_b128 v[48:51], v11 offset:28672
    s_mov_b32 s77, 0x3dd53b95
    s_waitcnt lgkmcnt(4)
    v_add_f32 v20, v20, v28
    v_add_f32 v21, v21, v29
    v_add_f32 v22, v22, v30
    v_add_f32 v23, v23, v31
    v_add_f32 v24, v24, v32
    v_add_f32 v25, v25, v33
    v_add_f32 v26, v26, v34
    v_add_f32 v27, v27, v35
    s_waitcnt lgkmcnt(0)
    v_add_f32 v36, v36, v44
    v_add_f32 v37, v37, v45
    v_add_f32 v38, v38, v46
    v_add_f32 v39, v39, v47
    v_add_f32 v40, v40, v48
    v_add_f32 v41, v41, v49
    v_add_f32 v42, v42, v50
    v_add_f32 v43, v43, v51
    v_add_f32 v20, v20, v36
    v_add_f32 v21, v21, v37
    v_add_f32 v22, v22, v38
    v_add_f32 v23, v23, v39
    v_add_f32 v24, v24, v40
    v_add_f32 v25, v25, v41
    v_add_f32 v26, v26, v42
    v_add_f32 v27, v27, v43
    v_mul_f32 v20, s77, v20
    v_mul_f32 v21, s77, v21
    v_mul_f32 v22, s77, v22
    v_mul_f32 v23, s77, v23
    v_mul_f32 v24, s77, v24
    v_mul_f32 v25, s77, v25
    v_mul_f32 v26, s77, v26
    v_mul_f32 v27, s77, v27
    v_max3_f32 v28, v20, v21, v22
    v_max3_f32 v29, v24, v25, v26
    v_max_f32 v28, v28, v23
    v_max_f32 v29, v29, v27
    v_mov_b32 v30, v28
    v_mov_b32 v31, v29
    s_nop 1
    v_permlane32_swap_b32 v28, v30
    v_permlane32_swap_b32 v29, v31
    s_nop 1
    v_max_f32 v28, v28, v30
    v_max_f32 v29, v29, v31
    v_ceil_f32 v28, v28
    v_ceil_f32 v29, v29
    v_sub_f32 v20, v20, v28
    v_sub_f32 v21, v21, v28
    v_sub_f32 v22, v22, v28
    v_sub_f32 v23, v23, v28
    v_sub_f32 v24, v24, v29
    v_sub_f32 v25, v25, v29
    v_sub_f32 v26, v26, v29
    v_sub_f32 v27, v27, v29
    v_exp_f32 v20, v20
    v_exp_f32 v21, v21
    v_exp_f32 v22, v22
    v_exp_f32 v23, v23
    v_exp_f32 v24, v24
    v_exp_f32 v25, v25
    v_exp_f32 v26, v26
    v_exp_f32 v27, v27
    v_min_u32 v28, 0xfffffffe, v28
    v_min_u32 v29, 0xfffffffe, v29
    v_cvt_pk_bf16_f32 v32, v20, v21
    v_cvt_pk_bf16_f32 v33, v22, v23
    v_cvt_pk_bf16_f32 v34, v24, v25
    v_cvt_pk_bf16_f32 v35, v26, v27
    v_and_b32 v32, 0x7fff7fff, v32
    v_and_b32 v33, 0x7fff7fff, v33
    v_and_b32 v34, 0x7fff7fff, v34
    v_and_b32 v35, 0x7fff7fff, v35
    s_add_u32 s81, s79, 1703936
    s_add_u32 s82, s80, 1703936
    buffer_store_dwordx2 v[32:33], v12, s[64:67], s81 offen
    buffer_store_dwordx2 v[34:35], v12, s[64:67], s81 offen offset:2560
    buffer_store_dword v28, v13, s[64:67], s82 offen
    buffer_store_dword v29, v13, s[64:67], s82 offen offset:2560
    s_add_u32 s81, s79, 1048576
    s_add_u32 s82, s80, 1048576
    buffer_store_dwordx2 v[32:33], v12, s[64:67], s81 offen sc1
    buffer_store_dwordx2 v[34:35], v12, s[64:67], s81 offen offset:2560 sc1
    buffer_store_dword v28, v13, s[64:67], s82 offen sc1
    buffer_store_dword v29, v13, s[64:67], s82 offen offset:2560 sc1
    v_mov_b32 v6, 2080
    s_mov_b32 s96, 0
L_poll_27:
    ds_read_b128 v[60:63], v6
    s_waitcnt lgkmcnt(0)
    v_and_b32 v60, v60, v61
    v_and_b32 v62, v62, v63
    v_and_b32 v60, v60, v62
    v_xor_b32 v60, 1, v60
    v_cmp_ne_u32 vcc, 0, v60
    s_cbranch_vccz L_ok_28
    s_add_u32 s96, s96, 1
    s_cmp_lt_u32 s96, 100000
    s_cbranch_scc1 L_poll_27
L_ok_28:
    v_lshrrev_b32 v14, 4, v1
    v_and_b32 v15, 15, v1
    v_lshrrev_b32 v16, 2, v15
    v_lshl_add_u32 v16, v14, 3, v16
    v_mul_u32_u24 v16, 192, v16
    v_and_b32 v15, 3, v15
    v_lshl_add_u32 v16, v15, 3, v16
    s_lshr_b32 s9, s3, 1
    s_and_b32 s9, s9, 1
    s_mul_i32 s9, s9, 96
    s_add_u32 s9, s9, 8192
    v_add_u32 v16, s9, v16
    ds_read_b64_tr_b16 v[84:85], v16 offset:0
    ds_read_b64_tr_b16 v[86:87], v16 offset:768
    ds_read_b64_tr_b16 v[88:89], v16 offset:32
    ds_read_b64_tr_b16 v[90:91], v16 offset:800
    ds_read_b64_tr_b16 v[92:93], v16 offset:64
    ds_read_b64_tr_b16 v[94:95], v16 offset:832
    ds_read_b64_tr_b16 v[96:97], v16 offset:6144
    ds_read_b64_tr_b16 v[98:99], v16 offset:6912
    ds_read_b64_tr_b16 v[100:101], v16 offset:6176
    ds_read_b64_tr_b16 v[102:103], v16 offset:6944
    ds_read_b64_tr_b16 v[104:105], v16 offset:6208
    ds_read_b64_tr_b16 v[106:107], v16 offset:6976
    s_waitcnt lgkmcnt(6)
    ds_read_b64_tr_b16 v[108:109], v16 offset:12288
    ds_read_b64_tr_b16 v[110:111], v16 offset:13056
    ds_read_b64_tr_b16 v[112:113], v16 offset:12320
    ds_read_b64_tr_b16 v[114:115], v16 offset:13088
    ds_read_b64_tr_b16 v[116:117], v16 offset:12352
    ds_read_b64_tr_b16 v[118:119], v16 offset:13120
    ds_read_b64_tr_b16 v[120:121], v16 offset:18432
    ds_read_b64_tr_b16 v[122:123], v16 offset:19200
    ds_read_b64_tr_b16 v[124:125], v16 offset:18464
    ds_read_b64_tr_b16 v[126:127], v16 offset:19232
    ds_read_b64_tr_b16 v[128:129], v16 offset:18496
    ds_read_b64_tr_b16 v[130:131], v16 offset:19264
    s_waitcnt lgkmcnt(6)
    ds_read_b64_tr_b16 v[132:133], v16 offset:24576
    ds_read_b64_tr_b16 v[134:135], v16 offset:25344
    ds_read_b64_tr_b16 v[136:137], v16 offset:24608
    ds_read_b64_tr_b16 v[138:139], v16 offset:25376
    ds_read_b64_tr_b16 v[140:141], v16 offset:24640
    ds_read_b64_tr_b16 v[142:143], v16 offset:25408
    ds_read_b64_tr_b16 v[144:145], v16 offset:30720
    ds_read_b64_tr_b16 v[146:147], v16 offset:31488
    ds_read_b64_tr_b16 v[148:149], v16 offset:30752
    ds_read_b64_tr_b16 v[150:151], v16 offset:31520
    ds_read_b64_tr_b16 v[152:153], v16 offset:30784
    ds_read_b64_tr_b16 v[154:155], v16 offset:31552
    s_waitcnt lgkmcnt(6)
    ds_read_b64_tr_b16 v[156:157], v16 offset:36864
    ds_read_b64_tr_b16 v[158:159], v16 offset:37632
    ds_read_b64_tr_b16 v[160:161], v16 offset:36896
    ds_read_b64_tr_b16 v[162:163], v16 offset:37664
    ds_read_b64_tr_b16 v[164:165], v16 offset:36928
    ds_read_b64_tr_b16 v[166:167], v16 offset:37696
    ds_read_b64_tr_b16 v[168:169], v16 offset:43008
    ds_read_b64_tr_b16 v[170:171], v16 offset:43776
    ds_read_b64_tr_b16 v[172:173], v16 offset:43040
    ds_read_b64_tr_b16 v[174:175], v16 offset:43808
    ds_read_b64_tr_b16 v[176:177], v16 offset:43072
    ds_read_b64_tr_b16 v[178:179], v16 offset:43840
    s_waitcnt lgkmcnt(6)
    s_branch L_j4_13
L_notS_12:
    s_barrier
    s_sub_u32 s84, s3, 4
    s_lshl_b32 s82, s12, 9
    s_mul_i32 s83, s84, 64
    s_add_u32 s82, s82, s83
    s_mul_i32 s82, s82, 1536
    s_mul_i32 s83, s13, 192
    s_add_u32 s82, s82, s83
    s_mul_i32 s83, s84, 12288
    s_add_u32 s83, s83, 106496
    s_add_u32 m0, s83, 0
    s_nop 0
    buffer_load_dwordx4 v212, s[20:23], s82 offen lds
    s_add_u32 m0, s83, 1024
    s_nop 0
    buffer_load_dwordx4 v213, s[20:23], s82 offen lds
    s_add_u32 m0, s83, 2048
    s_nop 0
    buffer_load_dwordx4 v214, s[20:23], s82 offen lds
    s_add_u32 m0, s83, 3072
    s_add_u32 s82, s82, 24576
    buffer_load_dwordx4 v212, s[20:23], s82 offen lds
    s_add_u32 m0, s83, 4096
    s_nop 0
    buffer_load_dwordx4 v213, s[20:23], s82 offen lds
    s_add_u32 m0, s83, 5120
    s_nop 0
    buffer_load_dwordx4 v214, s[20:23], s82 offen lds
    s_add_u32 m0, s83, 6144
    s_add_u32 s82, s82, 24576
    buffer_load_dwordx4 v212, s[20:23], s82 offen lds
    s_add_u32 m0, s83, 7168
    s_nop 0
    buffer_load_dwordx4 v213, s[20:23], s82 offen lds
    s_add_u32 m0, s83, 8192
    s_nop 0
    buffer_load_dwordx4 v214, s[20:23], s82 offen lds
    s_add_u32 m0, s83, 9216
    s_add_u32 s82, s82, 24576
    buffer_load_dwordx4 v212, s[20:23], s82 offen lds
    s_add_u32 m0, s83, 10240
    s_nop 0
    buffer_load_dwordx4 v213, s[20:23], s82 offen lds
    s_add_u32 m0, s83, 11264
    s_nop 0
    buffer_load_dwordx4 v214, s[20:23], s82 offen lds
    s_sub_u32 s84, s3, 4
    s_lshl_b32 s82, s12, 9
    s_mul_i32 s83, s84, 64
    s_add_u32 s82, s82, s83
    s_add_u32 s82, s82, 256
    s_mul_i32 s82, s82, 1536
    s_mul_i32 s83, s13, 192
    s_add_u32 s82, s82, s83
    s_mul_i32 s83, s84, 12288
    s_add_u32 s83, s83, 8192
    s_add_u32 m0, s83, 0
    s_nop 0
    buffer_load_dwordx4 v212, s[20:23], s82 offen lds
    s_add_u32 m0, s83, 1024
    s_nop 0
    buffer_load_dwordx4 v213, s[20:23], s82 offen lds
    s_add_u32 m0, s83, 2048
    s_nop 0
    buffer_load_dwordx4 v214, s[20:23], s82 offen lds
    s_add_u32 m0, s83, 3072
    s_add_u32 s82, s82, 24576
    buffer_load_dwordx4 v212, s[20:23], s82 offen lds
    s_add_u32 m0, s83, 4096
    s_nop 0
    buffer_load_dwordx4 v213, s[20:23], s82 offen lds
    s_add_u32 m0, s83, 5120
    s_nop 0
    buffer_load_dwordx4 v214, s[20:23], s82 offen lds
    s_add_u32 m0, s83, 6144
    s_add_u32 s82, s82, 24576
    buffer_load_dwordx4 v212, s[20:23], s82 offen lds
    s_add_u32 m0, s83, 7168
    s_nop 0
    buffer_load_dwordx4 v213, s[20:23], s82 offen lds
    s_add_u32 m0, s83, 8192
    s_nop 0
    buffer_load_dwordx4 v214, s[20:23], s82 offen lds
    s_add_u32 m0, s83, 9216
    s_add_u32 s82, s82, 24576
    buffer_load_dwordx4 v212, s[20:23], s82 offen lds
    s_add_u32 m0, s83, 10240
    s_nop 0
    buffer_load_dwordx4 v213, s[20:23], s82 offen lds
    s_add_u32 m0, s83, 11264
    s_nop 0
    buffer_load_dwordx4 v214, s[20:23], s82 offen lds
    s_waitcnt vmcnt(12)
    s_and_b32 s9, s3, 3
    s_lshl_b32 s9, s9, 2
    s_add_u32 s9, s9, 2048
    v_mov_b32 v6, s9
    v_mov_b32 v7, 1
    ds_write_b32 v6, v7
    v_mov_b32 v6, 2048
    s_mov_b32 s96, 0
L_poll_29:
    ds_read_b128 v[20:23], v6
    s_waitcnt lgkmcnt(0)
    v_and_b32 v20, v20, v21
    v_and_b32 v22, v22, v23
    v_and_b32 v20, v20, v22
    v_xor_b32 v20, 1, v20
    v_cmp_ne_u32 vcc, 0, v20
    s_cbranch_vccz L_ok_30
    s_add_u32 s96, s96, 1
    s_cmp_lt_u32 s96, 100000
    s_cbranch_scc1 L_poll_29
L_ok_30:
    v_lshrrev_b32 v14, 4, v1
    v_and_b32 v15, 15, v1
    v_lshrrev_b32 v16, 2, v15
    v_lshl_add_u32 v16, v14, 3, v16
    v_mul_u32_u24 v16, 192, v16
    v_and_b32 v15, 3, v15
    v_lshl_add_u32 v16, v15, 3, v16
    s_lshr_b32 s9, s3, 1
    s_and_b32 s9, s9, 1
    s_mul_i32 s9, s9, 96
    s_add_u32 s9, s9, 106496
    v_add_u32 v16, s9, v16
    ds_read_b64_tr_b16 v[84:85], v16 offset:0
    ds_read_b64_tr_b16 v[86:87], v16 offset:768
    ds_read_b64_tr_b16 v[88:89], v16 offset:32
    ds_read_b64_tr_b16 v[90:91], v16 offset:800
    ds_read_b64_tr_b16 v[92:93], v16 offset:64
    ds_read_b64_tr_b16 v[94:95], v16 offset:832
    ds_read_b64_tr_b16 v[96:97], v16 offset:6144
    ds_read_b64_tr_b16 v[98:99], v16 offset:6912
    ds_read_b64_tr_b16 v[100:101], v16 offset:6176
    ds_read_b64_tr_b16 v[102:103], v16 offset:6944
    ds_read_b64_tr_b16 v[104:105], v16 offset:6208
    ds_read_b64_tr_b16 v[106:107], v16 offset:6976
    s_waitcnt lgkmcnt(6)
    ds_read_b64_tr_b16 v[108:109], v16 offset:12288
    ds_read_b64_tr_b16 v[110:111], v16 offset:13056
    ds_read_b64_tr_b16 v[112:113], v16 offset:12320
    ds_read_b64_tr_b16 v[114:115], v16 offset:13088
    ds_read_b64_tr_b16 v[116:117], v16 offset:12352
    ds_read_b64_tr_b16 v[118:119], v16 offset:13120
    ds_read_b64_tr_b16 v[120:121], v16 offset:18432
    ds_read_b64_tr_b16 v[122:123], v16 offset:19200
    ds_read_b64_tr_b16 v[124:125], v16 offset:18464
    ds_read_b64_tr_b16 v[126:127], v16 offset:19232
    ds_read_b64_tr_b16 v[128:129], v16 offset:18496
    ds_read_b64_tr_b16 v[130:131], v16 offset:19264
    s_waitcnt lgkmcnt(6)
    ds_read_b64_tr_b16 v[132:133], v16 offset:24576
    ds_read_b64_tr_b16 v[134:135], v16 offset:25344
    ds_read_b64_tr_b16 v[136:137], v16 offset:24608
    ds_read_b64_tr_b16 v[138:139], v16 offset:25376
    ds_read_b64_tr_b16 v[140:141], v16 offset:24640
    ds_read_b64_tr_b16 v[142:143], v16 offset:25408
    ds_read_b64_tr_b16 v[144:145], v16 offset:30720
    ds_read_b64_tr_b16 v[146:147], v16 offset:31488
    ds_read_b64_tr_b16 v[148:149], v16 offset:30752
    ds_read_b64_tr_b16 v[150:151], v16 offset:31520
    ds_read_b64_tr_b16 v[152:153], v16 offset:30784
    ds_read_b64_tr_b16 v[154:155], v16 offset:31552
    s_waitcnt lgkmcnt(6)
    ds_read_b64_tr_b16 v[156:157], v16 offset:36864
    ds_read_b64_tr_b16 v[158:159], v16 offset:37632
    ds_read_b64_tr_b16 v[160:161], v16 offset:36896
    ds_read_b64_tr_b16 v[162:163], v16 offset:37664
    ds_read_b64_tr_b16 v[164:165], v16 offset:36928
    ds_read_b64_tr_b16 v[166:167], v16 offset:37696
    ds_read_b64_tr_b16 v[168:169], v16 offset:43008
    ds_read_b64_tr_b16 v[170:171], v16 offset:43776
    ds_read_b64_tr_b16 v[172:173], v16 offset:43040
    ds_read_b64_tr_b16 v[174:175], v16 offset:43808
    ds_read_b64_tr_b16 v[176:177], v16 offset:43072
    ds_read_b64_tr_b16 v[178:179], v16 offset:43840
    s_waitcnt lgkmcnt(6)
    s_waitcnt vmcnt(0)
    s_and_b32 s9, s3, 3
    s_lshl_b32 s9, s9, 2
    s_add_u32 s9, s9, 2080
    v_mov_b32 v6, s9
    v_mov_b32 v7, 1
    ds_write_b32 v6, v7
    s_cmp_lg_u32 s3, 4
    s_cbranch_scc1 L_nocf_31
    v_lshlrev_b32 v24, 4, v1
    s_mov_b32 s96, 0
L_poll_32:
    buffer_load_dwordx4 v[20:23], v24, s[64:67], s14 offen sc1
    s_waitcnt vmcnt(0)
    v_xor_b32 v20, s8, v20
    v_xor_b32 v21, s8, v21
    v_xor_b32 v22, s8, v22
    v_xor_b32 v23, s8, v23
    v_or3_b32 v20, v20, v21, v22
    v_or_b32 v20, v20, v23
    v_cmp_ne_u32 vcc, 0, v20
    s_cbranch_vccz L_ok_33
    s_add_u32 s96, s96, 1
    s_cmp_lt_u32 s96, 100000
    s_cbranch_scc1 L_poll_32
L_ok_33:
    v_mov_b32 v6, 2096
    v_mov_b32 v7, 1
    ds_write_b32 v6, v7
L_nocf_31:
L_j4_13:
    s_cmp_lt_u32 s3, 4
    s_cselect_b32 s74, 8, 0
    s_lshl_b32 s75, s12, 4
    s_add_u32 s75, s75, s74
    s_and_b32 s76, s3, 1
    s_mul_i32 s77, s75, 2560
    s_lshl_b32 s78, s76, 10
    s_add_u32 s77, s77, s78
    s_add_u32 s78, s77, 1048576
    s_add_u32 s77, s77, 1703936
    v_lshlrev_b32 v5, 4, v1
    v_and_b32 v6, 15, v1
    v_lshlrev_b32 v6, 2, v6
    v_lshrrev_b32 v7, 4, v1
    v_lshl_add_u32 v6, v7, 7, v6
    s_mul_i32 s79, s76, 960
    s_sub_u32 s79, 2048, s79
    v_add_u32 v6, s79, v6
    v_mov_b32 v196, 0x3f803f80
    v_mov_b32 v197, 0x3f803f80
    v_mov_b32 v198, 0x3f803f80
    v_mov_b32 v199, 0x3f803f80
    v_and_b32 v14, 15, v1
    s_mov_b32 s79, 49152
    v_mul_lo_u32 v15, v14, s79
    v_lshl_add_u32 v15, v7, 4, v15
    s_mul_i32 s79, s76, 786432
    s_lshl_b32 s80, s13, 4
    s_add_u32 s80, s80, s12
    s_mul_i32 s80, s80, 384
    s_add_u32 s79, s79, s80
    s_lshr_b32 s80, s3, 1
    s_and_b32 s80, s80, 1
    s_mul_i32 s81, s80, 192
    s_add_u32 s79, s79, s81
    s_add_u32 s79, s79, 2752512
    v_lshlrev_b32 v14, 7, v14
    v_mov_b32 v16, 0x7fffffff
    v_cmp_gt_u32 vcc, 16, v1
    s_lshl_b32 s82, s76, 11
    s_lshl_b32 s81, s12, 3
    s_add_u32 s82, s82, s81
    s_add_u32 s82, s82, 2359296
    v_cndmask_b32 v14, v16, v14, vcc
    s_or_b32 s81, s80, s13
    s_cmp_eq_u32 s81, 0
    s_cselect_b32 s82, s82, 0x7fffff00
    s_and_b32 s83, s3, 3
    s_lshl_b32 s83, s83, 12
    s_add_u32 s83, s83, 90112
    v_add_u32 v17, s83, v5
    v_mov_b32 v7, 2096
    s_mov_b32 s96, 0
L_poll_34:
    ds_read_b32 v8, v7
    s_waitcnt lgkmcnt(0)
    v_xor_b32 v8, 1, v8
    v_cmp_ne_u32 vcc, 0, v8
    s_cbranch_vccz L_ok_35
    s_add_u32 s96, s96, 1
    s_cmp_lt_u32 s96, 100000
    s_cbranch_scc1 L_poll_34
L_ok_35:
    s_mov_b32 s15, 255
    s_mov_b32 s96, 0
    s_mov_b64 s[24:25], -1
    s_mov_b64 s[26:27], -1
    s_mov_b64 s[28:29], -1
    s_mov_b64 s[30:31], -1
    s_mov_b64 s[32:33], -1
    s_mov_b64 s[34:35], -1
    s_mov_b64 s[36:37], -1
    s_mov_b64 s[38:39], -1
L_gp_36:
    s_and_b32 s9, s96, 7
    s_cmp_eq_u32 s9, 7
    s_cselect_b32 s97, s78, s77
    s_bitcmp0_b32 s15, 0
    s_cbranch_scc1 L_gi_38
    s_mov_b64 exec, s[24:25]
    s_add_u32 s9, s97, 0
    buffer_load_dwordx4 v[20:23], v5, s[64:67], s9 offen sc1
    buffer_load_dword v52, v6, s[64:67], s9 offen sc1
L_gi_38:
    s_bitcmp0_b32 s15, 1
    s_cbranch_scc1 L_gi_39
    s_mov_b64 exec, s[26:27]
    s_add_u32 s9, s97, 2560
    buffer_load_dwordx4 v[24:27], v5, s[64:67], s9 offen sc1
    buffer_load_dword v53, v6, s[64:67], s9 offen sc1
L_gi_39:
    s_bitcmp0_b32 s15, 2
    s_cbranch_scc1 L_gi_40
    s_mov_b64 exec, s[28:29]
    s_add_u32 s9, s97, 5120
    buffer_load_dwordx4 v[28:31], v5, s[64:67], s9 offen sc1
    buffer_load_dword v54, v6, s[64:67], s9 offen sc1
L_gi_40:
    s_bitcmp0_b32 s15, 3
    s_cbranch_scc1 L_gi_41
    s_mov_b64 exec, s[30:31]
    s_add_u32 s9, s97, 7680
    buffer_load_dwordx4 v[32:35], v5, s[64:67], s9 offen sc1
    buffer_load_dword v55, v6, s[64:67], s9 offen sc1
L_gi_41:
    s_bitcmp0_b32 s15, 4
    s_cbranch_scc1 L_gi_42
    s_mov_b64 exec, s[32:33]
    s_add_u32 s9, s97, 10240
    buffer_load_dwordx4 v[36:39], v5, s[64:67], s9 offen sc1
    buffer_load_dword v56, v6, s[64:67], s9 offen sc1
L_gi_42:
    s_bitcmp0_b32 s15, 5
    s_cbranch_scc1 L_gi_43
    s_mov_b64 exec, s[34:35]
    s_add_u32 s9, s97, 12800
    buffer_load_dwordx4 v[40:43], v5, s[64:67], s9 offen sc1
    buffer_load_dword v57, v6, s[64:67], s9 offen sc1
L_gi_43:
    s_bitcmp0_b32 s15, 6
    s_cbranch_scc1 L_gi_44
    s_mov_b64 exec, s[36:37]
    s_add_u32 s9, s97, 15360
    buffer_load_dwordx4 v[44:47], v5, s[64:67], s9 offen sc1
    buffer_load_dword v58, v6, s[64:67], s9 offen sc1
L_gi_44:
    s_bitcmp0_b32 s15, 7
    s_cbranch_scc1 L_gi_45
    s_mov_b64 exec, s[38:39]
    s_add_u32 s9, s97, 17920
    buffer_load_dwordx4 v[48:51], v5, s[64:67], s9 offen sc1
    buffer_load_dword v59, v6, s[64:67], s9 offen sc1
L_gi_45:
    s_mov_b64 exec, -1
    s_waitcnt vmcnt(0)
    s_bitcmp0_b32 s15, 0
    s_cbranch_scc1 L_gc_46
    v_or3_b32 v7, v20, v21, v22
    v_or_b32 v7, v7, v23
    v_and_b32 v7, 0x80008000, v7
    v_cmp_eq_u32 vcc, -1, v52
    s_nop 1
    v_cndmask_b32 v8, 0, 1, vcc
    v_or_b32 v7, v7, v8
    v_cmp_ne_u32 vcc, 0, v7
    s_mov_b64 s[24:25], vcc
    s_cbranch_vccnz L_gc_46
    s_bitset0_b32 s15, 0
L_gc_46:
    s_bitcmp0_b32 s15, 1
    s_cbranch_scc1 L_gc_47
    v_or3_b32 v7, v24, v25, v26
    v_or_b32 v7, v7, v27
    v_and_b32 v7, 0x80008000, v7
    v_cmp_eq_u32 vcc, -1, v53
    s_nop 1
    v_cndmask_b32 v8, 0, 1, vcc
    v_or_b32 v7, v7, v8
    v_cmp_ne_u32 vcc, 0, v7
    s_mov_b64 s[26:27], vcc
    s_cbranch_vccnz L_gc_47
    s_bitset0_b32 s15, 1
L_gc_47:
    s_bitcmp0_b32 s15, 2
    s_cbranch_scc1 L_gc_48
    v_or3_b32 v7, v28, v29, v30
    v_or_b32 v7, v7, v31
    v_and_b32 v7, 0x80008000, v7
    v_cmp_eq_u32 vcc, -1, v54
    s_nop 1
    v_cndmask_b32 v8, 0, 1, vcc
    v_or_b32 v7, v7, v8
    v_cmp_ne_u32 vcc, 0, v7
    s_mov_b64 s[28:29], vcc
    s_cbranch_vccnz L_gc_48
    s_bitset0_b32 s15, 2
L_gc_48:
    s_bitcmp0_b32 s15, 3
    s_cbranch_scc1 L_gc_49
    v_or3_b32 v7, v32, v33, v34
    v_or_b32 v7, v7, v35
    v_and_b32 v7, 0x80008000, v7
    v_cmp_eq_u32 vcc, -1, v55
    s_nop 1
    v_cndmask_b32 v8, 0, 1, vcc
    v_or_b32 v7, v7, v8
    v_cmp_ne_u32 vcc, 0, v7
    s_mov_b64 s[30:31], vcc
    s_cbranch_vccnz L_gc_49
    s_bitset0_b32 s15, 3
L_gc_49:
    s_bitcmp0_b32 s15, 4
    s_cbranch_scc1 L_gc_50
    v_or3_b32 v7, v36, v37, v38
    v_or_b32 v7, v7, v39
    v_and_b32 v7, 0x80008000, v7
    v_cmp_eq_u32 vcc, -1, v56
    s_nop 1
    v_cndmask_b32 v8, 0, 1, vcc
    v_or_b32 v7, v7, v8
    v_cmp_ne_u32 vcc, 0, v7
    s_mov_b64 s[32:33], vcc
    s_cbranch_vccnz L_gc_50
    s_bitset0_b32 s15, 4
L_gc_50:
    s_bitcmp0_b32 s15, 5
    s_cbranch_scc1 L_gc_51
    v_or3_b32 v7, v40, v41, v42
    v_or_b32 v7, v7, v43
    v_and_b32 v7, 0x80008000, v7
    v_cmp_eq_u32 vcc, -1, v57
    s_nop 1
    v_cndmask_b32 v8, 0, 1, vcc
    v_or_b32 v7, v7, v8
    v_cmp_ne_u32 vcc, 0, v7
    s_mov_b64 s[34:35], vcc
    s_cbranch_vccnz L_gc_51
    s_bitset0_b32 s15, 5
L_gc_51:
    s_bitcmp0_b32 s15, 6
    s_cbranch_scc1 L_gc_52
    v_or3_b32 v7, v44, v45, v46
    v_or_b32 v7, v7, v47
    v_and_b32 v7, 0x80008000, v7
    v_cmp_eq_u32 vcc, -1, v58
    s_nop 1
    v_cndmask_b32 v8, 0, 1, vcc
    v_or_b32 v7, v7, v8
    v_cmp_ne_u32 vcc, 0, v7
    s_mov_b64 s[36:37], vcc
    s_cbranch_vccnz L_gc_52
    s_bitset0_b32 s15, 6
L_gc_52:
    s_bitcmp0_b32 s15, 7
    s_cbranch_scc1 L_gc_53
    v_or3_b32 v7, v48, v49, v50
    v_or_b32 v7, v7, v51
    v_and_b32 v7, 0x80008000, v7
    v_cmp_eq_u32 vcc, -1, v59
    s_nop 1
    v_cndmask_b32 v8, 0, 1, vcc
    v_or_b32 v7, v7, v8
    v_cmp_ne_u32 vcc, 0, v7
    s_mov_b64 s[38:39], vcc
    s_cbranch_vccnz L_gc_53
    s_bitset0_b32 s15, 7
L_gc_53:
    s_cmp_eq_u32 s15, 0
    s_cbranch_scc1 L_gpd_37
    s_add_u32 s96, s96, 1
    s_cmp_lt_u32 s96, 100000
    s_cbranch_scc1 L_gp_36
L_gpd_37:
    v_max3_f32 v9, v52, v53, v54
    v_max3_f32 v9, v9, v55, v56
    v_max3_f32 v9, v9, v57, v58
    v_max_f32 v9, v9, v59
    v_mov_b32 v10, v9
    s_nop 1
    v_permlane16_swap_b32 v9, v10
    s_nop 1
    v_max_f32 v9, v9, v10
    v_mov_b32 v10, v9
    s_nop 1
    v_permlane32_swap_b32 v9, v10
    s_nop 1
    v_max_f32 v9, v9, v10
    s_mov_b32 s84, 0x437f0000
    s_mov_b32 s85, 0x00800080
    v_sub_f32 v60, v9, v52
    v_sub_f32 v61, v9, v53
    v_sub_f32 v62, v9, v54
    v_sub_f32 v63, v9, v55
    v_sub_f32 v64, v9, v56
    v_sub_f32 v65, v9, v57
    v_sub_f32 v66, v9, v58
    v_sub_f32 v67, v9, v59
    v_min_f32 v60, s84, v60
    v_min_f32 v61, s84, v61
    v_min_f32 v62, s84, v62
    v_min_f32 v63, s84, v63
    v_min_f32 v64, s84, v64
    v_min_f32 v65, s84, v65
    v_min_f32 v66, s84, v66
    v_min_f32 v67, s84, v67
    v_cvt_u32_f32 v60, v60
    v_cvt_u32_f32 v61, v61
    v_cvt_u32_f32 v62, v62
    v_cvt_u32_f32 v63, v63
    v_cvt_u32_f32 v64, v64
    v_cvt_u32_f32 v65, v65
    v_cvt_u32_f32 v66, v66
    v_cvt_u32_f32 v67, v67
    v_mul_u32_u24 v60, s85, v60
    v_mul_u32_u24 v61, s85, v61
    v_mul_u32_u24 v62, s85, v62
    v_mul_u32_u24 v63, s85, v63
    v_mul_u32_u24 v64, s85, v64
    v_mul_u32_u24 v65, s85, v65
    v_mul_u32_u24 v66, s85, v66
    v_mul_u32_u24 v67, s85, v67
    v_pk_sub_u16 v20, v20, v60 clamp
    v_pk_sub_u16 v21, v21, v60 clamp
    v_pk_sub_u16 v22, v22, v60 clamp
    v_pk_sub_u16 v23, v23, v60 clamp
    v_pk_sub_u16 v24, v24, v61 clamp
    v_pk_sub_u16 v25, v25, v61 clamp
    v_pk_sub_u16 v26, v26, v61 clamp
    v_pk_sub_u16 v27, v27, v61 clamp
    v_mfma_f32_16x16x32_bf16 v[180:183], v[84:87], v[20:23], 0
    v_mfma_f32_16x16x32_bf16 v[184:187], v[88:91], v[20:23], 0
    v_mfma_f32_16x16x32_bf16 v[188:191], v[92:95], v[20:23], 0
    v_mfma_f32_16x16x32_bf16 v[192:195], v[196:199], v[20:23], 0
    v_pk_sub_u16 v28, v28, v62 clamp
    v_pk_sub_u16 v29, v29, v62 clamp
    v_pk_sub_u16 v30, v30, v62 clamp
    v_pk_sub_u16 v31, v31, v62 clamp
    v_mfma_f32_16x16x32_bf16 v[180:183], v[96:99], v[24:27], v[180:183]
    v_mfma_f32_16x16x32_bf16 v[184:187], v[100:103], v[24:27], v[184:187]
    v_mfma_f32_16x16x32_bf16 v[188:191], v[104:107], v[24:27], v[188:191]
    v_mfma_f32_16x16x32_bf16 v[192:195], v[196:199], v[24:27], v[192:195]
    v_pk_sub_u16 v32, v32, v63 clamp
    v_pk_sub_u16 v33, v33, v63 clamp
    v_pk_sub_u16 v34, v34, v63 clamp
    v_pk_sub_u16 v35, v35, v63 clamp
    v_mfma_f32_16x16x32_bf16 v[180:183], v[108:111], v[28:31], v[180:183]
    v_mfma_f32_16x16x32_bf16 v[184:187], v[112:115], v[28:31], v[184:187]
    v_mfma_f32_16x16x32_bf16 v[188:191], v[116:119], v[28:31], v[188:191]
    v_mfma_f32_16x16x32_bf16 v[192:195], v[196:199], v[28:31], v[192:195]
    v_pk_sub_u16 v36, v36, v64 clamp
    v_pk_sub_u16 v37, v37, v64 clamp
    v_pk_sub_u16 v38, v38, v64 clamp
    v_pk_sub_u16 v39, v39, v64 clamp
    v_mfma_f32_16x16x32_bf16 v[180:183], v[120:123], v[32:35], v[180:183]
    v_mfma_f32_16x16x32_bf16 v[184:187], v[124:127], v[32:35], v[184:187]
    v_mfma_f32_16x16x32_bf16 v[188:191], v[128:131], v[32:35], v[188:191]
    v_mfma_f32_16x16x32_bf16 v[192:195], v[196:199], v[32:35], v[192:195]
    v_pk_sub_u16 v40, v40, v65 clamp
    v_pk_sub_u16 v41, v41, v65 clamp
    v_pk_sub_u16 v42, v42, v65 clamp
    v_pk_sub_u16 v43, v43, v65 clamp
    v_mfma_f32_16x16x32_bf16 v[180:183], v[132:135], v[36:39], v[180:183]
    v_mfma_f32_16x16x32_bf16 v[184:187], v[136:139], v[36:39], v[184:187]
    v_mfma_f32_16x16x32_bf16 v[188:191], v[140:143], v[36:39], v[188:191]
    v_mfma_f32_16x16x32_bf16 v[192:195], v[196:199], v[36:39], v[192:195]
    v_pk_sub_u16 v44, v44, v66 clamp
    v_pk_sub_u16 v45, v45, v66 clamp
    v_pk_sub_u16 v46, v46, v66 clamp
    v_pk_sub_u16 v47, v47, v66 clamp
    v_mfma_f32_16x16x32_bf16 v[180:183], v[144:147], v[40:43], v[180:183]
    v_mfma_f32_16x16x32_bf16 v[184:187], v[148:151], v[40:43], v[184:187]
    v_mfma_f32_16x16x32_bf16 v[188:191], v[152:155], v[40:43], v[188:191]
    v_mfma_f32_16x16x32_bf16 v[192:195], v[196:199], v[40:43], v[192:195]
    v_pk_sub_u16 v48, v48, v67 clamp
    v_pk_sub_u16 v49, v49, v67 clamp
    v_pk_sub_u16 v50, v50, v67 clamp
    v_pk_sub_u16 v51, v51, v67 clamp
    v_mfma_f32_16x16x32_bf16 v[180:183], v[156:159], v[44:47], v[180:183]
    v_mfma_f32_16x16x32_bf16 v[184:187], v[160:163], v[44:47], v[184:187]
    v_mfma_f32_16x16x32_bf16 v[188:191], v[164:167], v[44:47], v[188:191]
    v_mfma_f32_16x16x32_bf16 v[192:195], v[196:199], v[44:47], v[192:195]
    s_nop 1
    v_mfma_f32_16x16x32_bf16 v[180:183], v[168:171], v[48:51], v[180:183]
    v_mfma_f32_16x16x32_bf16 v[184:187], v[172:175], v[48:51], v[184:187]
    v_mfma_f32_16x16x32_bf16 v[188:191], v[176:179], v[48:51], v[188:191]
    v_mfma_f32_16x16x32_bf16 v[192:195], v[196:199], v[48:51], v[192:195]
    s_nop 7
    s_cmp_lt_u32 s3, 4
    s_cbranch_scc1 L_kp1_54
    v_mov_b32 v193, v9
    ds_write_b128 v17, v[180:183] offset:0
    ds_write_b128 v17, v[184:187] offset:1024
    ds_write_b128 v17, v[188:191] offset:2048
    ds_write_b128 v17, v[192:195] offset:3072
    s_waitcnt lgkmcnt(0)
L_kp1_54:
    s_barrier
    s_cmp_ge_u32 s3, 4
    s_cbranch_scc1 L_pvfin_55
    ds_read_b128 v[20:23], v17 offset:0
    ds_read_b128 v[24:27], v17 offset:1024
    ds_read_b128 v[28:31], v17 offset:2048
    ds_read_b128 v[32:35], v17 offset:3072
    s_waitcnt lgkmcnt(0)
    v_max_f32 v10, v9, v33
    v_sub_f32 v11, v9, v10
    v_sub_f32 v12, v33, v10
    v_exp_f32 v11, v11
    v_exp_f32 v12, v12
    s_nop 0
    v_mul_f32 v180, v180, v11
    v_mul_f32 v181, v181, v11
    v_mul_f32 v182, v182, v11
    v_mul_f32 v183, v183, v11
    v_mul_f32 v184, v184, v11
    v_mul_f32 v185, v185, v11
    v_mul_f32 v186, v186, v11
    v_mul_f32 v187, v187, v11
    v_mul_f32 v188, v188, v11
    v_mul_f32 v189, v189, v11
    v_mul_f32 v190, v190, v11
    v_mul_f32 v191, v191, v11
    v_fmac_f32 v180, v20, v12
    v_fmac_f32 v181, v21, v12
    v_fmac_f32 v182, v22, v12
    v_fmac_f32 v183, v23, v12
    v_fmac_f32 v184, v24, v12
    v_fmac_f32 v185, v25, v12
    v_fmac_f32 v186, v26, v12
    v_fmac_f32 v187, v27, v12
    v_fmac_f32 v188, v28, v12
    v_fmac_f32 v189, v29, v12
    v_fmac_f32 v190, v30, v12
    v_fmac_f32 v191, v31, v12
    v_min_u32 v180, 0xfffffffe, v180
    v_min_u32 v181, 0xfffffffe, v181
    v_min_u32 v182, 0xfffffffe, v182
    v_min_u32 v183, 0xfffffffe, v183
    v_min_u32 v184, 0xfffffffe, v184
    v_min_u32 v185, 0xfffffffe, v185
    v_min_u32 v186, 0xfffffffe, v186
    v_min_u32 v187, 0xfffffffe, v187
    v_min_u32 v188, 0xfffffffe, v188
    v_min_u32 v189, 0xfffffffe, v189
    v_min_u32 v190, 0xfffffffe, v190
    v_min_u32 v191, 0xfffffffe, v191
    buffer_store_dwordx4 v[180:183], v15, s[64:67], s79 offen offset:0 sc1
    buffer_store_dwordx4 v[184:187], v15, s[64:67], s79 offen offset:64 sc1
    buffer_store_dwordx4 v[188:191], v15, s[64:67], s79 offen offset:128 sc1
    v_mul_f32 v192, v192, v11
    v_fmac_f32 v192, v32, v12
    v_min_u32 v11, 0xfffffffe, v192
    v_min_u32 v10, 0xfffffffe, v10
    buffer_store_dwordx2 v[10:11], v14, s[64:67], s82 offen sc1
L_pvfin_55:
    s_branch L_bfin
L_aback:
    v_mul_u32_u24 v6, 52429, v0
    v_lshrrev_b32 v6, 22, v6
    v_mul_u32_u24 v7, 80, v6
    v_sub_u32 v7, v0, v7
    v_mul_u32_u24 v5, 1280, v6
    v_lshl_add_u32 v5, v7, 4, v5
    v_mov_b32 v8, 0x7fffffff
    v_cmp_gt_u32 vcc, 480, v0
    s_nop 1
    v_cndmask_b32 v5, v8, v5, vcc
    v_mul_u32_u24 v129, 2560, v6
    v_lshl_add_u32 v129, v7, 5, v129
    v_lshlrev_b32 v131, 4, v0
    v_mov_b32 v130, 0x7fffffff
    v_cmp_gt_u32 vcc, 160, v0
    s_nop 1
    v_cndmask_b32 v130, v130, v131, vcc
    s_cmp_ge_u32 s5, 12
    s_cbranch_scc1 L_bbranch
    s_mul_i32 s74, s3, 1179648
    s_mul_i32 s75, s6, 384
    s_add_u32 s74, s74, s75
    s_lshl_b32 s75, s7, 7
    s_add_u32 s74, s74, s75
    buffer_load_dwordx4 v[20:23], v4, s[32:35], s74 offen
    s_add_u32 s74, s74, 98304
    buffer_load_dwordx4 v[24:27], v4, s[32:35], s74 offen
    s_add_u32 s74, s74, 98304
    buffer_load_dwordx4 v[28:31], v4, s[32:35], s74 offen
    s_add_u32 s74, s74, 98304
    buffer_load_dwordx4 v[32:35], v4, s[32:35], s74 offen
    s_add_u32 s74, s74, 98304
    buffer_load_dwordx4 v[36:39], v4, s[32:35], s74 offen
    s_add_u32 s74, s74, 98304
    buffer_load_dwordx4 v[40:43], v4, s[32:35], s74 offen
    s_add_u32 s74, s74, 98304
    buffer_load_dwordx4 v[44:47], v4, s[32:35], s74 offen
    s_add_u32 s74, s74, 98304
    buffer_load_dwordx4 v[48:51], v4, s[32:35], s74 offen
    s_add_u32 s74, s74, 98304
    buffer_load_dwordx4 v[52:55], v4, s[32:35], s74 offen
    s_add_u32 s74, s74, 98304
    buffer_load_dwordx4 v[56:59], v4, s[32:35], s74 offen
    s_add_u32 s74, s74, 98304
    buffer_load_dwordx4 v[60:63], v4, s[32:35], s74 offen
    s_add_u32 s74, s74, 98304
    buffer_load_dwordx4 v[64:67], v4, s[32:35], s74 offen
    s_mul_i32 s74, s6, 192
    s_lshl_b32 s75, s7, 6
    s_add_u32 s74, s74, s75
    s_mul_i32 s74, s74, 1280
    buffer_load_dwordx4 v[68:71], v5, s[36:39], s74 offen
    s_add_u32 s74, s74, 7680
    buffer_load_dwordx4 v[72:75], v5, s[36:39], s74 offen
    s_add_u32 s74, s74, 7680
    buffer_load_dwordx4 v[76:79], v5, s[36:39], s74 offen
    s_add_u32 s74, s74, 7680
    buffer_load_dwordx4 v[80:83], v5, s[36:39], s74 offen
    s_add_u32 s74, s74, 7680
    buffer_load_dwordx4 v[84:87], v5, s[36:39], s74 offen
    s_add_u32 s74, s74, 7680
    buffer_load_dwordx4 v[88:91], v5, s[36:39], s74 offen
    s_add_u32 s74, s74, 7680
    buffer_load_dwordx4 v[92:95], v5, s[36:39], s74 offen
    s_add_u32 s74, s74, 7680
    buffer_load_dwordx4 v[96:99], v5, s[36:39], s74 offen
    s_add_u32 s74, s74, 7680
    buffer_load_dwordx4 v[100:103], v5, s[36:39], s74 offen
    s_add_u32 s74, s74, 7680
    buffer_load_dwordx4 v[104:107], v5, s[36:39], s74 offen
    s_add_u32 s74, s74, 7680
    v_cmp_gt_u32 vcc, 4, v6
    s_nop 1
    v_cndmask_b32 v9, v8, v5, vcc
    buffer_load_dwordx4 v[108:111], v9, s[36:39], s74 offen
    v_mov_b32 v112, 0
    v_mov_b32 v113, 0
    v_mov_b32 v114, 0
    v_mov_b32 v115, 0
    v_cmp_le_u32 vcc, 24, v1
    s_nop 1
    v_cndmask_b32 v10, 0, 1, vcc
    v_mul_u32_u24 v11, 24, v10
    v_sub_u32 v11, v1, v11
    v_mul_u32_u24 v12, 384, v10
    v_lshl_add_u32 v12, v11, 4, v12
    s_lshl_b32 s76, s3, 10
    s_add_u32 s76, s76, 4096
    v_add_u32 v13, s76, v12
    v_cmp_gt_u32 vcc, 48, v1
    v_lshlrev_b32 v16, 2, v2
    v_add_u32 v16, s76, v16
    v_cndmask_b32 v12, v8, v12, vcc
    s_lshl_b32 s74, s6, 3
    s_add_u32 s74, s74, s3
    s_mul_i32 s74, s74, 6144
    s_add_u32 s74, s74, 2752512
    s_lshl_b32 s75, s6, 7
    s_add_u32 s75, s75, 2359296
    v_and_b32 v14, 15, v1
    v_lshlrev_b32 v14, 3, v14
    v_lshlrev_b32 v121, 2, v10
    v_lshlrev_b32 v17, 5, v3
    v_lshl_add_u32 v17, v2, 2, v17
    s_lshl_b32 s77, s3, 8
    v_add_u32 v17, s77, v17
    v_lshlrev_b32 v18, 2, v6
    v_lshlrev_b32 v172, 2, v1
    v_add_u32 v173, 14314, v172
    v_add_u32 v172, 14336, v172
    v_mov_b32 v174, 14836
    v_cmp_gt_u32 vcc, 6, v1
    s_nop 1
    v_cndmask_b32 v173, v173, v174, vcc
    s_waitcnt vmcnt(11)
    s_mov_b32 s94, 0x05040100
    s_mov_b32 s95, 0x07060302
    v_perm_b32 v128, v24, v20, s94
    v_perm_b32 v24, v24, v20, s95
    v_mov_b32 v20, v128
    v_perm_b32 v128, v25, v21, s94
    v_perm_b32 v25, v25, v21, s95
    v_mov_b32 v21, v128
    v_perm_b32 v128, v26, v22, s94
    v_perm_b32 v26, v26, v22, s95
    v_mov_b32 v22, v128
    v_perm_b32 v128, v27, v23, s94
    v_perm_b32 v27, v27, v23, s95
    v_mov_b32 v23, v128
    v_perm_b32 v128, v32, v28, s94
    v_perm_b32 v32, v32, v28, s95
    v_mov_b32 v28, v128
    v_perm_b32 v128, v33, v29, s94
    v_perm_b32 v33, v33, v29, s95
    v_mov_b32 v29, v128
    v_perm_b32 v128, v34, v30, s94
    v_perm_b32 v34, v34, v30, s95
    v_mov_b32 v30, v128
    v_perm_b32 v128, v35, v31, s94
    v_perm_b32 v35, v35, v31, s95
    v_mov_b32 v31, v128
    v_perm_b32 v128, v40, v36, s94
    v_perm_b32 v40, v40, v36, s95
    v_mov_b32 v36, v128
    v_perm_b32 v128, v41, v37, s94
    v_perm_b32 v41, v41, v37, s95
    v_mov_b32 v37, v128
    v_perm_b32 v128, v42, v38, s94
    v_perm_b32 v42, v42, v38, s95
    v_mov_b32 v38, v128
    v_perm_b32 v128, v43, v39, s94
    v_perm_b32 v43, v43, v39, s95
    v_mov_b32 v39, v128
    v_perm_b32 v128, v48, v44, s94
    v_perm_b32 v48, v48, v44, s95
    v_mov_b32 v44, v128
    v_perm_b32 v128, v49, v45, s94
    v_perm_b32 v49, v49, v45, s95
    v_mov_b32 v45, v128
    v_perm_b32 v128, v50, v46, s94
    v_perm_b32 v50, v50, v46, s95
    v_mov_b32 v46, v128
    v_perm_b32 v128, v51, v47, s94
    v_perm_b32 v51, v51, v47, s95
    v_mov_b32 v47, v128
    v_perm_b32 v128, v56, v52, s94
    v_perm_b32 v56, v56, v52, s95
    v_mov_b32 v52, v128
    v_perm_b32 v128, v57, v53, s94
    v_perm_b32 v57, v57, v53, s95
    v_mov_b32 v53, v128
    v_perm_b32 v128, v58, v54, s94
    v_perm_b32 v58, v58, v54, s95
    v_mov_b32 v54, v128
    v_perm_b32 v128, v59, v55, s94
    v_perm_b32 v59, v59, v55, s95
    v_mov_b32 v55, v128
    v_perm_b32 v128, v64, v60, s94
    v_perm_b32 v64, v64, v60, s95
    v_mov_b32 v60, v128
    v_perm_b32 v128, v65, v61, s94
    v_perm_b32 v65, v65, v61, s95
    v_mov_b32 v61, v128
    v_perm_b32 v128, v66, v62, s94
    v_perm_b32 v66, v66, v62, s95
    v_mov_b32 v62, v128
    v_perm_b32 v128, v67, v63, s94
    v_perm_b32 v67, v67, v63, s95
    v_mov_b32 v63, v128
    s_waitcnt vmcnt(0)
    s_mov_b32 s94, 0x05040100
    s_mov_b32 s95, 0x07060302
    v_perm_b32 v128, v72, v68, s94
    v_perm_b32 v72, v72, v68, s95
    v_mov_b32 v68, v128
    v_perm_b32 v128, v73, v69, s94
    v_perm_b32 v73, v73, v69, s95
    v_mov_b32 v69, v128
    v_perm_b32 v128, v74, v70, s94
    v_perm_b32 v74, v74, v70, s95
    v_mov_b32 v70, v128
    v_perm_b32 v128, v75, v71, s94
    v_perm_b32 v75, v75, v71, s95
    v_mov_b32 v71, v128
    v_perm_b32 v128, v80, v76, s94
    v_perm_b32 v80, v80, v76, s95
    v_mov_b32 v76, v128
    v_perm_b32 v128, v81, v77, s94
    v_perm_b32 v81, v81, v77, s95
    v_mov_b32 v77, v128
    v_perm_b32 v128, v82, v78, s94
    v_perm_b32 v82, v82, v78, s95
    v_mov_b32 v78, v128
    v_perm_b32 v128, v83, v79, s94
    v_perm_b32 v83, v83, v79, s95
    v_mov_b32 v79, v128
    v_perm_b32 v128, v88, v84, s94
    v_perm_b32 v88, v88, v84, s95
    v_mov_b32 v84, v128
    v_perm_b32 v128, v89, v85, s94
    v_perm_b32 v89, v89, v85, s95
    v_mov_b32 v85, v128
    v_perm_b32 v128, v90, v86, s94
    v_perm_b32 v90, v90, v86, s95
    v_mov_b32 v86, v128
    v_perm_b32 v128, v91, v87, s94
    v_perm_b32 v91, v91, v87, s95
    v_mov_b32 v87, v128
    v_perm_b32 v128, v96, v92, s94
    v_perm_b32 v96, v96, v92, s95
    v_mov_b32 v92, v128
    v_perm_b32 v128, v97, v93, s94
    v_perm_b32 v97, v97, v93, s95
    v_mov_b32 v93, v128
    v_perm_b32 v128, v98, v94, s94
    v_perm_b32 v98, v98, v94, s95
    v_mov_b32 v94, v128
    v_perm_b32 v128, v99, v95, s94
    v_perm_b32 v99, v99, v95, s95
    v_mov_b32 v95, v128
    v_perm_b32 v128, v104, v100, s94
    v_perm_b32 v104, v104, v100, s95
    v_mov_b32 v100, v128
    v_perm_b32 v128, v105, v101, s94
    v_perm_b32 v105, v105, v101, s95
    v_mov_b32 v101, v128
    v_perm_b32 v128, v106, v102, s94
    v_perm_b32 v106, v106, v102, s95
    v_mov_b32 v102, v128
    v_perm_b32 v128, v107, v103, s94
    v_perm_b32 v107, v107, v103, s95
    v_mov_b32 v103, v128
    v_perm_b32 v128, v112, v108, s94
    v_perm_b32 v112, v112, v108, s95
    v_mov_b32 v108, v128
    v_perm_b32 v128, v113, v109, s94
    v_perm_b32 v113, v113, v109, s95
    v_mov_b32 v109, v128
    v_perm_b32 v128, v114, v110, s94
    v_perm_b32 v114, v114, v110, s95
    v_mov_b32 v110, v128
    v_perm_b32 v128, v115, v111, s94
    v_perm_b32 v115, v115, v111, s95
    v_mov_b32 v111, v128
    v_lshlrev_b32 v136, 4, v1
    s_mov_b32 s96, 0
L_poll_56:
    buffer_load_dwordx4 v[132:135], v136, s[64:67], s14 offen sc1
    s_waitcnt vmcnt(0)
    v_xor_b32 v132, s8, v132
    v_xor_b32 v133, s8, v133
    v_xor_b32 v134, s8, v134
    v_xor_b32 v135, s8, v135
    v_or3_b32 v132, v132, v133, v134
    v_or_b32 v132, v132, v135
    v_cmp_ne_u32 vcc, 0, v132
    s_cbranch_vccz L_ok_57
    s_add_u32 s96, s96, 1
    s_cmp_lt_u32 s96, 100000
    s_cbranch_scc1 L_poll_56
L_ok_57:
    s_add_u32 s76, s74, 3072
    s_mov_b32 s96, 0
L_mla_58:
    buffer_load_dwordx2 v[116:117], v14, s[64:67], s75 offen sc1
    s_waitcnt vmcnt(0)
    v_max_u32 v15, v116, v117
    v_cmp_ne_u32 vcc, -1, v15
    s_cbranch_vccnz L_mlo_59
    s_sleep 2
    s_add_u32 s96, s96, 1
    s_cmp_lt_u32 s96, 100000
    s_cbranch_scc1 L_mla_58
L_mlo_59:
    s_mov_b32 s15, 511
    s_mov_b32 s96, 0
    s_mov_b64 s[20:21], -1
    s_mov_b64 s[22:23], -1
    s_mov_b64 s[24:25], -1
    s_mov_b64 s[26:27], -1
    s_mov_b64 s[28:29], -1
    s_mov_b64 s[30:31], -1
    s_mov_b64 s[44:45], -1
    s_mov_b64 s[46:47], -1
    s_mov_b64 s[48:49], -1
L_gp_60:
    s_bitcmp0_b32 s15, 0
    s_cbranch_scc1 L_gi_62
    s_mov_b64 exec, s[20:21]
    buffer_load_dwordx4 v[132:135], v12, s[64:67], s74 offen offset:0 sc1
L_gi_62:
    s_bitcmp0_b32 s15, 1
    s_cbranch_scc1 L_gi_63
    s_mov_b64 exec, s[22:23]
    buffer_load_dwordx4 v[136:139], v12, s[64:67], s74 offen offset:768 sc1
L_gi_63:
    s_bitcmp0_b32 s15, 2
    s_cbranch_scc1 L_gi_64
    s_mov_b64 exec, s[24:25]
    buffer_load_dwordx4 v[140:143], v12, s[64:67], s74 offen offset:1536 sc1
L_gi_64:
    s_bitcmp0_b32 s15, 3
    s_cbranch_scc1 L_gi_65
    s_mov_b64 exec, s[26:27]
    buffer_load_dwordx4 v[144:147], v12, s[64:67], s74 offen offset:2304 sc1
L_gi_65:
    s_bitcmp0_b32 s15, 4
    s_cbranch_scc1 L_gi_66
    s_mov_b64 exec, s[28:29]
    buffer_load_dwordx4 v[148:151], v12, s[64:67], s76 offen offset:0 sc1
L_gi_66:
    s_bitcmp0_b32 s15, 5
    s_cbranch_scc1 L_gi_67
    s_mov_b64 exec, s[30:31]
    buffer_load_dwordx4 v[152:155], v12, s[64:67], s76 offen offset:768 sc1
L_gi_67:
    s_bitcmp0_b32 s15, 6
    s_cbranch_scc1 L_gi_68
    s_mov_b64 exec, s[44:45]
    buffer_load_dwordx4 v[156:159], v12, s[64:67], s76 offen offset:1536 sc1
L_gi_68:
    s_bitcmp0_b32 s15, 7
    s_cbranch_scc1 L_gi_69
    s_mov_b64 exec, s[46:47]
    buffer_load_dwordx4 v[160:163], v12, s[64:67], s76 offen offset:2304 sc1
L_gi_69:
    s_bitcmp0_b32 s15, 8
    s_cbranch_scc1 L_gi_70
    s_mov_b64 exec, s[48:49]
    buffer_load_dwordx2 v[116:117], v14, s[64:67], s75 offen sc1
L_gi_70:
    s_mov_b64 exec, -1
    s_waitcnt vmcnt(0)
    s_bitcmp0_b32 s15, 0
    s_cbranch_scc1 L_gc_71
    v_max3_u32 v15, v132, v133, v134
    v_max_u32 v15, v15, v135
    v_cmp_eq_u32 vcc, -1, v15
    s_mov_b64 s[20:21], vcc
    s_cbranch_vccnz L_gc_71
    s_bitset0_b32 s15, 0
L_gc_71:
    s_bitcmp0_b32 s15, 1
    s_cbranch_scc1 L_gc_72
    v_max3_u32 v15, v136, v137, v138
    v_max_u32 v15, v15, v139
    v_cmp_eq_u32 vcc, -1, v15
    s_mov_b64 s[22:23], vcc
    s_cbranch_vccnz L_gc_72
    s_bitset0_b32 s15, 1
L_gc_72:
    s_bitcmp0_b32 s15, 2
    s_cbranch_scc1 L_gc_73
    v_max3_u32 v15, v140, v141, v142
    v_max_u32 v15, v15, v143
    v_cmp_eq_u32 vcc, -1, v15
    s_mov_b64 s[24:25], vcc
    s_cbranch_vccnz L_gc_73
    s_bitset0_b32 s15, 2
L_gc_73:
    s_bitcmp0_b32 s15, 3
    s_cbranch_scc1 L_gc_74
    v_max3_u32 v15, v144, v145, v146
    v_max_u32 v15, v15, v147
    v_cmp_eq_u32 vcc, -1, v15
    s_mov_b64 s[26:27], vcc
    s_cbranch_vccnz L_gc_74
    s_bitset0_b32 s15, 3
L_gc_74:
    s_bitcmp0_b32 s15, 4
    s_cbranch_scc1 L_gc_75
    v_max3_u32 v15, v148, v149, v150
    v_max_u32 v15, v15, v151
    v_cmp_eq_u32 vcc, -1, v15
    s_mov_b64 s[28:29], vcc
    s_cbranch_vccnz L_gc_75
    s_bitset0_b32 s15, 4
L_gc_75:
    s_bitcmp0_b32 s15, 5
    s_cbranch_scc1 L_gc_76
    v_max3_u32 v15, v152, v153, v154
    v_max_u32 v15, v15, v155
    v_cmp_eq_u32 vcc, -1, v15
    s_mov_b64 s[30:31], vcc
    s_cbranch_vccnz L_gc_76
    s_bitset0_b32 s15, 5
L_gc_76:
    s_bitcmp0_b32 s15, 6
    s_cbranch_scc1 L_gc_77
    v_max3_u32 v15, v156, v157, v158
    v_max_u32 v15, v15, v159
    v_cmp_eq_u32 vcc, -1, v15
    s_mov_b64 s[44:45], vcc
    s_cbranch_vccnz L_gc_77
    s_bitset0_b32 s15, 6
L_gc_77:
    s_bitcmp0_b32 s15, 7
    s_cbranch_scc1 L_gc_78
    v_max3_u32 v15, v160, v161, v162
    v_max_u32 v15, v15, v163
    v_cmp_eq_u32 vcc, -1, v15
    s_mov_b64 s[46:47], vcc
    s_cbranch_vccnz L_gc_78
    s_bitset0_b32 s15, 7
L_gc_78:
    s_bitcmp0_b32 s15, 8
    s_cbranch_scc1 L_gc_79
    v_max_u32 v15, v116, v117
    v_cmp_eq_u32 vcc, -1, v15
    s_mov_b64 s[48:49], vcc
    s_cbranch_vccnz L_gc_79
    s_bitset0_b32 s15, 8
L_gc_79:
    s_cmp_eq_u32 s15, 0
    s_cbranch_scc1 L_gpd_61
    s_add_u32 s96, s96, 1
    s_cmp_lt_u32 s96, 100000
    s_cbranch_scc1 L_gp_60
L_gpd_61:
    v_mov_b32 v118, v116
    s_nop 1
    v_max_f32_dpp v118, v118, v118 quad_perm:[1,0,3,2] row_mask:0xf bank_mask:0xf
    s_nop 1
    v_max_f32_dpp v118, v118, v118 quad_perm:[2,3,0,1] row_mask:0xf bank_mask:0xf
    s_nop 1
    v_max_f32_dpp v118, v118, v118 row_half_mirror row_mask:0xf bank_mask:0xf
    s_nop 1
    v_max_f32_dpp v118, v118, v118 row_mirror row_mask:0xf bank_mask:0xf
    s_nop 1
    v_sub_f32 v119, v116, v118
    v_exp_f32 v119, v119
    s_nop 0
    v_mul_f32 v120, v117, v119
    ds_bpermute_b32 v164, v121, v119 offset:0
    ds_bpermute_b32 v165, v121, v119 offset:8
    ds_bpermute_b32 v166, v121, v119 offset:16
    ds_bpermute_b32 v167, v121, v119 offset:24
    ds_bpermute_b32 v168, v121, v119 offset:32
    ds_bpermute_b32 v169, v121, v119 offset:40
    ds_bpermute_b32 v170, v121, v119 offset:48
    ds_bpermute_b32 v171, v121, v119 offset:56
    v_add_f32_dpp v120, v120, v120 quad_perm:[1,0,3,2] row_mask:0xf bank_mask:0xf
    s_nop 1
    v_add_f32_dpp v120, v120, v120 quad_perm:[2,3,0,1] row_mask:0xf bank_mask:0xf
    s_nop 1
    v_add_f32_dpp v120, v120, v120 row_half_mirror row_mask:0xf bank_mask:0xf
    s_nop 1
    v_add_f32_dpp v120, v120, v120 row_mirror row_mask:0xf bank_mask:0xf
    s_nop 1
    v_rcp_f32 v120, v120
    s_waitcnt lgkmcnt(0)
    v_mul_f32 v122, v164, v132
    v_mul_f32 v123, v164, v133
    v_mul_f32 v124, v164, v134
    v_mul_f32 v125, v164, v135
    v_fmac_f32 v122, v165, v136
    v_fmac_f32 v123, v165, v137
    v_fmac_f32 v124, v165, v138
    v_fmac_f32 v125, v165, v139
    v_fmac_f32 v122, v166, v140
    v_fmac_f32 v123, v166, v141
    v_fmac_f32 v124, v166, v142
    v_fmac_f32 v125, v166, v143
    v_fmac_f32 v122, v167, v144
    v_fmac_f32 v123, v167, v145
    v_fmac_f32 v124, v167, v146
    v_fmac_f32 v125, v167, v147
    v_fmac_f32 v122, v168, v148
    v_fmac_f32 v123, v168, v149
    v_fmac_f32 v124, v168, v150
    v_fmac_f32 v125, v168, v151
    v_fmac_f32 v122, v169, v152
    v_fmac_f32 v123, v169, v153
    v_fmac_f32 v124, v169, v154
    v_fmac_f32 v125, v169, v155
    v_fmac_f32 v122, v170, v156
    v_fmac_f32 v123, v170, v157
    v_fmac_f32 v124, v170, v158
    v_fmac_f32 v125, v170, v159
    v_fmac_f32 v122, v171, v160
    v_fmac_f32 v123, v171, v161
    v_fmac_f32 v124, v171, v162
    v_fmac_f32 v125, v171, v163
    v_mul_f32 v122, v122, v120
    v_mul_f32 v123, v123, v120
    v_mul_f32 v124, v124, v120
    v_mul_f32 v125, v125, v120
    s_mov_b32 exec_hi, 0xffff
    ds_write_b128 v13, v[122:125]
    s_mov_b32 exec_hi, -1
    s_waitcnt lgkmcnt(0)
    ds_read2_b32 v[132:133], v16 offset0:0 offset1:96
    ds_read2_b32 v[134:135], v16 offset0:8 offset1:104
    ds_read2_b32 v[136:137], v16 offset0:16 offset1:112
    ds_read2_b32 v[138:139], v16 offset0:24 offset1:120
    ds_read2_b32 v[140:141], v16 offset0:32 offset1:128
    ds_read2_b32 v[142:143], v16 offset0:40 offset1:136
    ds_read2_b32 v[144:145], v16 offset0:48 offset1:144
    ds_read2_b32 v[146:147], v16 offset0:56 offset1:152
    ds_read2_b32 v[148:149], v16 offset0:64 offset1:160
    ds_read2_b32 v[150:151], v16 offset0:72 offset1:168
    ds_read2_b32 v[152:153], v16 offset0:80 offset1:176
    ds_read2_b32 v[154:155], v16 offset0:88 offset1:184
    v_mov_b32 v120, 0
    v_mov_b32 v121, 0
    v_mov_b32 v122, 0
    v_mov_b32 v123, 0
    v_mov_b32 v124, 0
    v_mov_b32 v125, 0
    v_mov_b32 v126, 0
    v_mov_b32 v127, 0
    s_waitcnt lgkmcnt(10)
    v_add_f32 v132, v132, v133
    v_add_f32 v134, v134, v135
    v_cvt_pk_bf16_f32 v160, v132, v134
    s_waitcnt lgkmcnt(8)
    v_add_f32 v136, v136, v137
    v_add_f32 v138, v138, v139
    v_cvt_pk_bf16_f32 v161, v136, v138
    s_waitcnt lgkmcnt(6)
    v_add_f32 v140, v140, v141
    v_add_f32 v142, v142, v143
    v_cvt_pk_bf16_f32 v162, v140, v142
    s_waitcnt lgkmcnt(4)
    v_add_f32 v144, v144, v145
    v_add_f32 v146, v146, v147
    v_cvt_pk_bf16_f32 v163, v144, v146
    s_waitcnt lgkmcnt(2)
    v_add_f32 v148, v148, v149
    v_add_f32 v150, v150, v151
    v_cvt_pk_bf16_f32 v164, v148, v150
    s_waitcnt lgkmcnt(0)
    v_add_f32 v152, v152, v153
    v_add_f32 v154, v154, v155
    v_cvt_pk_bf16_f32 v165, v152, v154
    v_dot2c_f32_bf16 v120, v20, v160
    v_dot2c_f32_bf16 v122, v21, v160
    v_dot2c_f32_bf16 v124, v22, v160
    v_dot2c_f32_bf16 v126, v23, v160
    v_dot2c_f32_bf16 v121, v24, v160
    v_dot2c_f32_bf16 v123, v25, v160
    v_dot2c_f32_bf16 v125, v26, v160
    v_dot2c_f32_bf16 v127, v27, v160
    v_dot2c_f32_bf16 v120, v28, v161
    v_dot2c_f32_bf16 v122, v29, v161
    v_dot2c_f32_bf16 v124, v30, v161
    v_dot2c_f32_bf16 v126, v31, v161
    v_dot2c_f32_bf16 v121, v32, v161
    v_dot2c_f32_bf16 v123, v33, v161
    v_dot2c_f32_bf16 v125, v34, v161
    v_dot2c_f32_bf16 v127, v35, v161
    v_dot2c_f32_bf16 v120, v36, v162
    v_dot2c_f32_bf16 v122, v37, v162
    v_dot2c_f32_bf16 v124, v38, v162
    v_dot2c_f32_bf16 v126, v39, v162
    v_dot2c_f32_bf16 v121, v40, v162
    v_dot2c_f32_bf16 v123, v41, v162
    v_dot2c_f32_bf16 v125, v42, v162
    v_dot2c_f32_bf16 v127, v43, v162
    v_dot2c_f32_bf16 v120, v44, v163
    v_dot2c_f32_bf16 v122, v45, v163
    v_dot2c_f32_bf16 v124, v46, v163
    v_dot2c_f32_bf16 v126, v47, v163
    v_dot2c_f32_bf16 v121, v48, v163
    v_dot2c_f32_bf16 v123, v49, v163
    v_dot2c_f32_bf16 v125, v50, v163
    v_dot2c_f32_bf16 v127, v51, v163
    v_dot2c_f32_bf16 v120, v52, v164
    v_dot2c_f32_bf16 v122, v53, v164
    v_dot2c_f32_bf16 v124, v54, v164
    v_dot2c_f32_bf16 v126, v55, v164
    v_dot2c_f32_bf16 v121, v56, v164
    v_dot2c_f32_bf16 v123, v57, v164
    v_dot2c_f32_bf16 v125, v58, v164
    v_dot2c_f32_bf16 v127, v59, v164
    v_dot2c_f32_bf16 v120, v60, v165
    v_dot2c_f32_bf16 v122, v61, v165
    v_dot2c_f32_bf16 v124, v62, v165
    v_dot2c_f32_bf16 v126, v63, v165
    v_dot2c_f32_bf16 v121, v64, v165
    v_dot2c_f32_bf16 v123, v65, v165
    v_dot2c_f32_bf16 v125, v66, v165
    v_dot2c_f32_bf16 v127, v67, v165
    s_nop 2
    v_permlane32_swap_b32 v120, v124
    v_permlane32_swap_b32 v121, v125
    v_permlane32_swap_b32 v122, v126
    v_permlane32_swap_b32 v123, v127
    s_nop 1
    v_add_f32 v120, v120, v124
    v_add_f32 v121, v121, v125
    v_add_f32 v122, v122, v126
    v_add_f32 v123, v123, v127
    s_nop 1
    v_permlane16_swap_b32 v120, v122
    v_permlane16_swap_b32 v121, v123
    s_nop 1
    v_add_f32 v120, v120, v122
    v_add_f32 v121, v121, v123
    s_nop 0
    v_cndmask_b32 v128, v120, v121, s[72:73]
    v_cndmask_b32 v118, v121, v120, s[72:73]
    s_nop 1
    v_add_f32_dpp v120, v118, v128 row_ror:8 row_mask:0xf bank_mask:0xf
    ds_write_b32 v17, v120 offset:12288
    s_waitcnt lgkmcnt(0)
    s_barrier
    s_cmp_lg_u32 s3, 0
    s_cbranch_scc1 L_cx_80
    v_lshlrev_b32 v13, 2, v1
    ds_read_b32 v132, v13 offset:12288
    ds_read_b32 v133, v13 offset:12544
    ds_read_b32 v134, v13 offset:12800
    ds_read_b32 v135, v13 offset:13056
    ds_read_b32 v136, v13 offset:13312
    ds_read_b32 v137, v13 offset:13568
    ds_read_b32 v138, v13 offset:13824
    ds_read_b32 v139, v13 offset:14080
    s_waitcnt lgkmcnt(0)
    v_add_f32 v132, v132, v133
    v_add_f32 v134, v134, v135
    v_add_f32 v136, v136, v137
    v_add_f32 v138, v138, v139
    v_add_f32 v132, v132, v134
    v_add_f32 v136, v136, v138
    v_add_f32 v132, v132, v136
    v_cvt_pk_bf16_f32 v132, v132, v132
    ds_write_b16 v172, v132
    ds_write_b16 v173, v132
    s_waitcnt lgkmcnt(0)
L_cx_80:
    v_mov_b32 v120, 0
    v_mov_b32 v121, 0
    v_mov_b32 v122, 0
    v_mov_b32 v123, 0
    v_mov_b32 v124, 0
    v_mov_b32 v125, 0
    v_mov_b32 v126, 0
    v_mov_b32 v127, 0
    s_barrier
    ds_read_b32 v160, v18 offset:14336
    ds_read_b32 v161, v18 offset:14384
    ds_read_b32 v162, v18 offset:14432
    ds_read_b32 v163, v18 offset:14480
    ds_read_b32 v164, v18 offset:14528
    ds_read_b32 v165, v18 offset:14576
    s_waitcnt lgkmcnt(0)
    v_dot2c_f32_bf16 v120, v68, v160
    v_dot2c_f32_bf16 v122, v69, v160
    v_dot2c_f32_bf16 v124, v70, v160
    v_dot2c_f32_bf16 v126, v71, v160
    v_dot2c_f32_bf16 v121, v72, v160
    v_dot2c_f32_bf16 v123, v73, v160
    v_dot2c_f32_bf16 v125, v74, v160
    v_dot2c_f32_bf16 v127, v75, v160
    v_dot2c_f32_bf16 v120, v76, v161
    v_dot2c_f32_bf16 v122, v77, v161
    v_dot2c_f32_bf16 v124, v78, v161
    v_dot2c_f32_bf16 v126, v79, v161
    v_dot2c_f32_bf16 v121, v80, v161
    v_dot2c_f32_bf16 v123, v81, v161
    v_dot2c_f32_bf16 v125, v82, v161
    v_dot2c_f32_bf16 v127, v83, v161
    v_dot2c_f32_bf16 v120, v84, v162
    v_dot2c_f32_bf16 v122, v85, v162
    v_dot2c_f32_bf16 v124, v86, v162
    v_dot2c_f32_bf16 v126, v87, v162
    v_dot2c_f32_bf16 v121, v88, v162
    v_dot2c_f32_bf16 v123, v89, v162
    v_dot2c_f32_bf16 v125, v90, v162
    v_dot2c_f32_bf16 v127, v91, v162
    v_dot2c_f32_bf16 v120, v92, v163
    v_dot2c_f32_bf16 v122, v93, v163
    v_dot2c_f32_bf16 v124, v94, v163
    v_dot2c_f32_bf16 v126, v95, v163
    v_dot2c_f32_bf16 v121, v96, v163
    v_dot2c_f32_bf16 v123, v97, v163
    v_dot2c_f32_bf16 v125, v98, v163
    v_dot2c_f32_bf16 v127, v99, v163
    v_dot2c_f32_bf16 v120, v100, v164
    v_dot2c_f32_bf16 v122, v101, v164
    v_dot2c_f32_bf16 v124, v102, v164
    v_dot2c_f32_bf16 v126, v103, v164
    v_dot2c_f32_bf16 v121, v104, v164
    v_dot2c_f32_bf16 v123, v105, v164
    v_dot2c_f32_bf16 v125, v106, v164
    v_dot2c_f32_bf16 v127, v107, v164
    v_dot2c_f32_bf16 v120, v108, v165
    v_dot2c_f32_bf16 v122, v109, v165
    v_dot2c_f32_bf16 v124, v110, v165
    v_dot2c_f32_bf16 v126, v111, v165
    v_dot2c_f32_bf16 v121, v112, v165
    v_dot2c_f32_bf16 v123, v113, v165
    v_dot2c_f32_bf16 v125, v114, v165
    v_dot2c_f32_bf16 v127, v115, v165
    s_nop 2
    ds_write_b128 v129, v[120:123] offset:16384
    ds_write_b128 v129, v[124:127] offset:16400
    s_waitcnt lgkmcnt(0)
    s_barrier
    s_cmp_ge_u32 s3, 3
    s_cbranch_scc1 L_go_81
    ds_read_b128 v[132:135], v131 offset:16384
    ds_read_b128 v[136:139], v131 offset:18944
    ds_read_b128 v[140:143], v131 offset:21504
    ds_read_b128 v[144:147], v131 offset:24064
    ds_read_b128 v[148:151], v131 offset:26624
    ds_read_b128 v[152:155], v131 offset:29184
    s_waitcnt lgkmcnt(0)
    v_add_f32 v132, v132, v136
    v_add_f32 v140, v140, v144
    v_add_f32 v148, v148, v152
    v_add_f32 v133, v133, v137
    v_add_f32 v141, v141, v145
    v_add_f32 v149, v149, v153
    v_add_f32 v134, v134, v138
    v_add_f32 v142, v142, v146
    v_add_f32 v150, v150, v154
    v_add_f32 v135, v135, v139
    v_add_f32 v143, v143, v147
    v_add_f32 v151, v151, v155
    v_add_f32 v132, v132, v140
    v_add_f32 v133, v133, v141
    v_add_f32 v134, v134, v142
    v_add_f32 v135, v135, v143
    v_add_f32 v132, v132, v148
    v_add_f32 v133, v133, v149
    v_add_f32 v134, v134, v150
    v_add_f32 v135, v135, v151
    v_min_u32 v132, 0xfffffffe, v132
    v_min_u32 v133, 0xfffffffe, v133
    v_min_u32 v134, 0xfffffffe, v134
    v_min_u32 v135, 0xfffffffe, v135
    buffer_store_dwordx4 v[132:135], v130, s[64:67], s84 offen sc1
L_go_81:
    s_branch L_aend
L_bbranch:
    v_lshlrev_b32 v19, 2, v6
    s_lshl_b32 s74, s4, 2
    s_add_u32 s74, s74, s5
    s_sub_u32 s74, s74, 12
    v_mul_u32_u24 v10, 43, v1
    v_lshrrev_b32 v10, 8, v10
    v_mul_u32_u24 v11, 6, v10
    v_sub_u32 v11, v1, v11
    v_mul_u32_u24 v12, 3072, v10
    v_lshl_add_u32 v12, v11, 4, v12
    v_cmp_gt_u32 vcc, 60, v1
    v_lshlrev_b32 v13, 1, v10
    s_nop 0
    v_cndmask_b32 v12, v8, v12, vcc
    s_and_b32 s75, s3, 3
    s_mul_i32 s76, s75, 320
    buffer_load_ushort v84, v13, s[16:19], s76 offen offset:0
    buffer_load_ushort v85, v13, s[16:19], s76 offen offset:20
    buffer_load_ushort v86, v13, s[16:19], s76 offen offset:40
    buffer_load_ushort v87, v13, s[16:19], s76 offen offset:60
    buffer_load_ushort v88, v13, s[16:19], s76 offen offset:80
    buffer_load_ushort v89, v13, s[16:19], s76 offen offset:100
    buffer_load_ushort v90, v13, s[16:19], s76 offen offset:120
    buffer_load_ushort v91, v13, s[16:19], s76 offen offset:140
    buffer_load_ushort v92, v13, s[16:19], s76 offen offset:160
    buffer_load_ushort v93, v13, s[16:19], s76 offen offset:180
    buffer_load_ushort v94, v13, s[16:19], s76 offen offset:200
    buffer_load_ushort v95, v13, s[16:19], s76 offen offset:220
    buffer_load_ushort v96, v13, s[16:19], s76 offen offset:240
    buffer_load_ushort v97, v13, s[16:19], s76 offen offset:260
    buffer_load_ushort v98, v13, s[16:19], s76 offen offset:280
    buffer_load_ushort v99, v13, s[16:19], s76 offen offset:300
    s_mul_i32 s76, s75, 491520
    s_mul_i32 s77, s74, 96
    s_add_u32 s76, s76, s77
    s_cmp_ge_u32 s3, 4
    s_cbranch_scc1 L_up_82
    buffer_load_dwordx4 v[20:23], v12, s[44:47], s76 offen
    s_add_u32 s76, s76, 30720
    buffer_load_dwordx4 v[24:27], v12, s[44:47], s76 offen
    s_add_u32 s76, s76, 30720
    buffer_load_dwordx4 v[28:31], v12, s[44:47], s76 offen
    s_add_u32 s76, s76, 30720
    buffer_load_dwordx4 v[32:35], v12, s[44:47], s76 offen
    s_add_u32 s76, s76, 30720
    buffer_load_dwordx4 v[36:39], v12, s[44:47], s76 offen
    s_add_u32 s76, s76, 30720
    buffer_load_dwordx4 v[40:43], v12, s[44:47], s76 offen
    s_add_u32 s76, s76, 30720
    buffer_load_dwordx4 v[44:47], v12, s[44:47], s76 offen
    s_add_u32 s76, s76, 30720
    buffer_load_dwordx4 v[48:51], v12, s[44:47], s76 offen
    s_add_u32 s76, s76, 30720
    buffer_load_dwordx4 v[52:55], v12, s[44:47], s76 offen
    s_add_u32 s76, s76, 30720
    buffer_load_dwordx4 v[56:59], v12, s[44:47], s76 offen
    s_add_u32 s76, s76, 30720
    buffer_load_dwordx4 v[60:63], v12, s[44:47], s76 offen
    s_add_u32 s76, s76, 30720
    buffer_load_dwordx4 v[64:67], v12, s[44:47], s76 offen
    s_add_u32 s76, s76, 30720
    buffer_load_dwordx4 v[68:71], v12, s[44:47], s76 offen
    s_add_u32 s76, s76, 30720
    buffer_load_dwordx4 v[72:75], v12, s[44:47], s76 offen
    s_add_u32 s76, s76, 30720
    buffer_load_dwordx4 v[76:79], v12, s[44:47], s76 offen
    s_add_u32 s76, s76, 30720
    buffer_load_dwordx4 v[80:83], v12, s[44:47], s76 offen
    s_add_u32 s76, s76, 30720
    s_branch L_upd_83
L_up_82:
    buffer_load_dwordx4 v[20:23], v12, s[48:51], s76 offen
    s_add_u32 s76, s76, 30720
    buffer_load_dwordx4 v[24:27], v12, s[48:51], s76 offen
    s_add_u32 s76, s76, 30720
    buffer_load_dwordx4 v[28:31], v12, s[48:51], s76 offen
    s_add_u32 s76, s76, 30720
    buffer_load_dwordx4 v[32:35], v12, s[48:51], s76 offen
    s_add_u32 s76, s76, 30720
    buffer_load_dwordx4 v[36:39], v12, s[48:51], s76 offen
    s_add_u32 s76, s76, 30720
    buffer_load_dwordx4 v[40:43], v12, s[48:51], s76 offen
    s_add_u32 s76, s76, 30720
    buffer_load_dwordx4 v[44:47], v12, s[48:51], s76 offen
    s_add_u32 s76, s76, 30720
    buffer_load_dwordx4 v[48:51], v12, s[48:51], s76 offen
    s_add_u32 s76, s76, 30720
    buffer_load_dwordx4 v[52:55], v12, s[48:51], s76 offen
    s_add_u32 s76, s76, 30720
    buffer_load_dwordx4 v[56:59], v12, s[48:51], s76 offen
    s_add_u32 s76, s76, 30720
    buffer_load_dwordx4 v[60:63], v12, s[48:51], s76 offen
    s_add_u32 s76, s76, 30720
    buffer_load_dwordx4 v[64:67], v12, s[48:51], s76 offen
    s_add_u32 s76, s76, 30720
    buffer_load_dwordx4 v[68:71], v12, s[48:51], s76 offen
    s_add_u32 s76, s76, 30720
    buffer_load_dwordx4 v[72:75], v12, s[48:51], s76 offen
    s_add_u32 s76, s76, 30720
    buffer_load_dwordx4 v[76:79], v12, s[48:51], s76 offen
    s_add_u32 s76, s76, 30720
    buffer_load_dwordx4 v[80:83], v12, s[48:51], s76 offen
    s_add_u32 s76, s76, 30720
L_upd_83:
    s_mul_i32 s76, s74, 61440
    buffer_load_dwordx4 v[160:163], v5, s[52:55], s76 offen
    s_add_u32 s76, s76, 7680
    buffer_load_dwordx4 v[164:167], v5, s[52:55], s76 offen
    s_add_u32 s76, s76, 7680
    buffer_load_dwordx4 v[168:171], v5, s[52:55], s76 offen
    s_add_u32 s76, s76, 7680
    buffer_load_dwordx4 v[172:175], v5, s[52:55], s76 offen
    s_add_u32 s76, s76, 7680
    buffer_load_dwordx4 v[176:179], v5, s[52:55], s76 offen
    s_add_u32 s76, s76, 7680
    buffer_load_dwordx4 v[180:183], v5, s[52:55], s76 offen
    s_add_u32 s76, s76, 7680
    buffer_load_dwordx4 v[184:187], v5, s[52:55], s76 offen
    s_add_u32 s76, s76, 7680
    buffer_load_dwordx4 v[188:191], v5, s[52:55], s76 offen
    s_add_u32 s76, s76, 7680
    v_mov_b32 v120, 0
    v_mov_b32 v121, 0
    v_mov_b32 v122, 0
    v_mov_b32 v123, 0
    v_mov_b32 v124, 0
    v_mov_b32 v125, 0
    v_mov_b32 v126, 0
    v_mov_b32 v127, 0
    s_waitcnt vmcnt(23)
    v_lshlrev_b32 v128, 16, v84
    v_dot2c_f32_bf16 v120, v20, v84
    v_dot2c_f32_bf16 v122, v21, v84
    v_dot2c_f32_bf16 v124, v22, v84
    v_dot2c_f32_bf16 v126, v23, v84
    v_dot2c_f32_bf16 v121, v20, v128
    v_dot2c_f32_bf16 v123, v21, v128
    v_dot2c_f32_bf16 v125, v22, v128
    v_dot2c_f32_bf16 v127, v23, v128
    s_waitcnt vmcnt(22)
    v_lshlrev_b32 v128, 16, v85
    v_dot2c_f32_bf16 v120, v24, v85
    v_dot2c_f32_bf16 v122, v25, v85
    v_dot2c_f32_bf16 v124, v26, v85
    v_dot2c_f32_bf16 v126, v27, v85
    v_dot2c_f32_bf16 v121, v24, v128
    v_dot2c_f32_bf16 v123, v25, v128
    v_dot2c_f32_bf16 v125, v26, v128
    v_dot2c_f32_bf16 v127, v27, v128
    s_waitcnt vmcnt(21)
    v_lshlrev_b32 v128, 16, v86
    v_dot2c_f32_bf16 v120, v28, v86
    v_dot2c_f32_bf16 v122, v29, v86
    v_dot2c_f32_bf16 v124, v30, v86
    v_dot2c_f32_bf16 v126, v31, v86
    v_dot2c_f32_bf16 v121, v28, v128
    v_dot2c_f32_bf16 v123, v29, v128
    v_dot2c_f32_bf16 v125, v30, v128
    v_dot2c_f32_bf16 v127, v31, v128
    s_waitcnt vmcnt(20)
    v_lshlrev_b32 v128, 16, v87
    v_dot2c_f32_bf16 v120, v32, v87
    v_dot2c_f32_bf16 v122, v33, v87
    v_dot2c_f32_bf16 v124, v34, v87
    v_dot2c_f32_bf16 v126, v35, v87
    v_dot2c_f32_bf16 v121, v32, v128
    v_dot2c_f32_bf16 v123, v33, v128
    v_dot2c_f32_bf16 v125, v34, v128
    v_dot2c_f32_bf16 v127, v35, v128
    s_waitcnt vmcnt(19)
    v_lshlrev_b32 v128, 16, v88
    v_dot2c_f32_bf16 v120, v36, v88
    v_dot2c_f32_bf16 v122, v37, v88
    v_dot2c_f32_bf16 v124, v38, v88
    v_dot2c_f32_bf16 v126, v39, v88
    v_dot2c_f32_bf16 v121, v36, v128
    v_dot2c_f32_bf16 v123, v37, v128
    v_dot2c_f32_bf16 v125, v38, v128
    v_dot2c_f32_bf16 v127, v39, v128
    s_waitcnt vmcnt(18)
    v_lshlrev_b32 v128, 16, v89
    v_dot2c_f32_bf16 v120, v40, v89
    v_dot2c_f32_bf16 v122, v41, v89
    v_dot2c_f32_bf16 v124, v42, v89
    v_dot2c_f32_bf16 v126, v43, v89
    v_dot2c_f32_bf16 v121, v40, v128
    v_dot2c_f32_bf16 v123, v41, v128
    v_dot2c_f32_bf16 v125, v42, v128
    v_dot2c_f32_bf16 v127, v43, v128
    s_waitcnt vmcnt(17)
    v_lshlrev_b32 v128, 16, v90
    v_dot2c_f32_bf16 v120, v44, v90
    v_dot2c_f32_bf16 v122, v45, v90
    v_dot2c_f32_bf16 v124, v46, v90
    v_dot2c_f32_bf16 v126, v47, v90
    v_dot2c_f32_bf16 v121, v44, v128
    v_dot2c_f32_bf16 v123, v45, v128
    v_dot2c_f32_bf16 v125, v46, v128
    v_dot2c_f32_bf16 v127, v47, v128
    s_waitcnt vmcnt(16)
    v_lshlrev_b32 v128, 16, v91
    v_dot2c_f32_bf16 v120, v48, v91
    v_dot2c_f32_bf16 v122, v49, v91
    v_dot2c_f32_bf16 v124, v50, v91
    v_dot2c_f32_bf16 v126, v51, v91
    v_dot2c_f32_bf16 v121, v48, v128
    v_dot2c_f32_bf16 v123, v49, v128
    v_dot2c_f32_bf16 v125, v50, v128
    v_dot2c_f32_bf16 v127, v51, v128
    s_waitcnt vmcnt(15)
    v_lshlrev_b32 v128, 16, v92
    v_dot2c_f32_bf16 v120, v52, v92
    v_dot2c_f32_bf16 v122, v53, v92
    v_dot2c_f32_bf16 v124, v54, v92
    v_dot2c_f32_bf16 v126, v55, v92
    v_dot2c_f32_bf16 v121, v52, v128
    v_dot2c_f32_bf16 v123, v53, v128
    v_dot2c_f32_bf16 v125, v54, v128
    v_dot2c_f32_bf16 v127, v55, v128
    s_waitcnt vmcnt(14)
    v_lshlrev_b32 v128, 16, v93
    v_dot2c_f32_bf16 v120, v56, v93
    v_dot2c_f32_bf16 v122, v57, v93
    v_dot2c_f32_bf16 v124, v58, v93
    v_dot2c_f32_bf16 v126, v59, v93
    v_dot2c_f32_bf16 v121, v56, v128
    v_dot2c_f32_bf16 v123, v57, v128
    v_dot2c_f32_bf16 v125, v58, v128
    v_dot2c_f32_bf16 v127, v59, v128
    s_waitcnt vmcnt(13)
    v_lshlrev_b32 v128, 16, v94
    v_dot2c_f32_bf16 v120, v60, v94
    v_dot2c_f32_bf16 v122, v61, v94
    v_dot2c_f32_bf16 v124, v62, v94
    v_dot2c_f32_bf16 v126, v63, v94
    v_dot2c_f32_bf16 v121, v60, v128
    v_dot2c_f32_bf16 v123, v61, v128
    v_dot2c_f32_bf16 v125, v62, v128
    v_dot2c_f32_bf16 v127, v63, v128
    s_waitcnt vmcnt(12)
    v_lshlrev_b32 v128, 16, v95
    v_dot2c_f32_bf16 v120, v64, v95
    v_dot2c_f32_bf16 v122, v65, v95
    v_dot2c_f32_bf16 v124, v66, v95
    v_dot2c_f32_bf16 v126, v67, v95
    v_dot2c_f32_bf16 v121, v64, v128
    v_dot2c_f32_bf16 v123, v65, v128
    v_dot2c_f32_bf16 v125, v66, v128
    v_dot2c_f32_bf16 v127, v67, v128
    s_waitcnt vmcnt(11)
    v_lshlrev_b32 v128, 16, v96
    v_dot2c_f32_bf16 v120, v68, v96
    v_dot2c_f32_bf16 v122, v69, v96
    v_dot2c_f32_bf16 v124, v70, v96
    v_dot2c_f32_bf16 v126, v71, v96
    v_dot2c_f32_bf16 v121, v68, v128
    v_dot2c_f32_bf16 v123, v69, v128
    v_dot2c_f32_bf16 v125, v70, v128
    v_dot2c_f32_bf16 v127, v71, v128
    s_waitcnt vmcnt(10)
    v_lshlrev_b32 v128, 16, v97
    v_dot2c_f32_bf16 v120, v72, v97
    v_dot2c_f32_bf16 v122, v73, v97
    v_dot2c_f32_bf16 v124, v74, v97
    v_dot2c_f32_bf16 v126, v75, v97
    v_dot2c_f32_bf16 v121, v72, v128
    v_dot2c_f32_bf16 v123, v73, v128
    v_dot2c_f32_bf16 v125, v74, v128
    v_dot2c_f32_bf16 v127, v75, v128
    s_waitcnt vmcnt(9)
    v_lshlrev_b32 v128, 16, v98
    v_dot2c_f32_bf16 v120, v76, v98
    v_dot2c_f32_bf16 v122, v77, v98
    v_dot2c_f32_bf16 v124, v78, v98
    v_dot2c_f32_bf16 v126, v79, v98
    v_dot2c_f32_bf16 v121, v76, v128
    v_dot2c_f32_bf16 v123, v77, v128
    v_dot2c_f32_bf16 v125, v78, v128
    v_dot2c_f32_bf16 v127, v79, v128
    s_waitcnt vmcnt(8)
    v_lshlrev_b32 v128, 16, v99
    v_dot2c_f32_bf16 v120, v80, v99
    v_dot2c_f32_bf16 v122, v81, v99
    v_dot2c_f32_bf16 v124, v82, v99
    v_dot2c_f32_bf16 v126, v83, v99
    v_dot2c_f32_bf16 v121, v80, v128
    v_dot2c_f32_bf16 v123, v81, v128
    v_dot2c_f32_bf16 v125, v82, v128
    v_dot2c_f32_bf16 v127, v83, v128
    s_mul_i32 s76, s3, 1920
    v_mul_u32_u24 v13, 192, v10
    v_lshl_add_u32 v13, v11, 5, v13
    v_add_u32 v13, s76, v13
    s_mov_b32 exec_hi, 0x0fffffff
    ds_write_b128 v13, v[120:123] offset:16384
    ds_write_b128 v13, v[124:127] offset:16400
    s_mov_b32 exec_hi, -1
    s_waitcnt lgkmcnt(0)
    s_barrier
    s_cmp_ge_u32 s3, 2
    s_cbranch_scc1 L_bg_84
    v_cmp_le_u32 vcc, 48, v0
    v_mov_b32 v14, 7488
    v_lshlrev_b32 v13, 2, v0
    v_cndmask_b32 v14, 0, v14, vcc
    v_add_u32 v13, v13, v14
    v_min_u32 v13, 7868, v13
    ds_read_b32 v20, v13 offset:16384
    ds_read_b32 v21, v13 offset:16576
    ds_read_b32 v22, v13 offset:16768
    ds_read_b32 v23, v13 offset:16960
    ds_read_b32 v24, v13 offset:17152
    ds_read_b32 v25, v13 offset:17344
    ds_read_b32 v26, v13 offset:17536
    ds_read_b32 v27, v13 offset:17728
    s_waitcnt lgkmcnt(0)
    ds_read_b32 v28, v13 offset:17920
    ds_read_b32 v29, v13 offset:18112
    ds_read_b32 v30, v13 offset:18304
    ds_read_b32 v31, v13 offset:18496
    ds_read_b32 v32, v13 offset:18688
    ds_read_b32 v33, v13 offset:18880
    ds_read_b32 v34, v13 offset:19072
    ds_read_b32 v35, v13 offset:19264
    s_waitcnt lgkmcnt(0)
    ds_read_b32 v36, v13 offset:19456
    ds_read_b32 v37, v13 offset:19648
    ds_read_b32 v38, v13 offset:19840
    ds_read_b32 v39, v13 offset:20032
    ds_read_b32 v40, v13 offset:20224
    ds_read_b32 v41, v13 offset:20416
    ds_read_b32 v42, v13 offset:20608
    ds_read_b32 v43, v13 offset:20800
    s_waitcnt lgkmcnt(0)
    ds_read_b32 v44, v13 offset:20992
    ds_read_b32 v45, v13 offset:21184
    ds_read_b32 v46, v13 offset:21376
    ds_read_b32 v47, v13 offset:21568
    ds_read_b32 v48, v13 offset:21760
    ds_read_b32 v49, v13 offset:21952
    ds_read_b32 v50, v13 offset:22144
    ds_read_b32 v51, v13 offset:22336
    s_waitcnt lgkmcnt(0)
    ds_read_b32 v52, v13 offset:22528
    ds_read_b32 v53, v13 offset:22720
    ds_read_b32 v54, v13 offset:22912
    ds_read_b32 v55, v13 offset:23104
    ds_read_b32 v56, v13 offset:23296
    ds_read_b32 v57, v13 offset:23488
    ds_read_b32 v58, v13 offset:23680
    ds_read_b32 v59, v13 offset:23872
    s_waitcnt lgkmcnt(0)
    v_add_f32 v20, v20, v21
    v_add_f32 v20, v20, v22
    v_add_f32 v20, v20, v23
    v_add_f32 v20, v20, v24
    v_add_f32 v20, v20, v25
    v_add_f32 v20, v20, v26
    v_add_f32 v20, v20, v27
    v_add_f32 v20, v20, v28
    v_add_f32 v20, v20, v29
    v_add_f32 v20, v20, v30
    v_add_f32 v20, v20, v31
    v_add_f32 v20, v20, v32
    v_add_f32 v20, v20, v33
    v_add_f32 v20, v20, v34
    v_add_f32 v20, v20, v35
    v_add_f32 v20, v20, v36
    v_add_f32 v20, v20, v37
    v_add_f32 v20, v20, v38
    v_add_f32 v20, v20, v39
    v_add_f32 v20, v20, v40
    v_add_f32 v20, v20, v41
    v_add_f32 v20, v20, v42
    v_add_f32 v20, v20, v43
    v_add_f32 v20, v20, v44
    v_add_f32 v20, v20, v45
    v_add_f32 v20, v20, v46
    v_add_f32 v20, v20, v47
    v_add_f32 v20, v20, v48
    v_add_f32 v20, v20, v49
    v_add_f32 v20, v20, v50
    v_add_f32 v20, v20, v51
    v_add_f32 v20, v20, v52
    v_add_f32 v20, v20, v53
    v_add_f32 v20, v20, v54
    v_add_f32 v20, v20, v55
    v_add_f32 v20, v20, v56
    v_add_f32 v20, v20, v57
    v_add_f32 v20, v20, v58
    v_add_f32 v20, v20, v59
    v_lshlrev_b32 v13, 2, v0
    ds_write_b32 v13, v20 offset:12288
    s_waitcnt lgkmcnt(0)
L_bg_84:
    s_barrier
    s_cmp_lg_u32 s3, 0
    s_cbranch_scc1 L_bh_85
    v_lshlrev_b32 v13, 2, v1
    ds_read_b32 v20, v13 offset:12288
    ds_read_b32 v21, v13 offset:12480
    s_waitcnt lgkmcnt(0)
    v_mul_f32 v20, 0xbfb8aa3b, v20
    v_exp_f32 v20, v20
    s_nop 0
    v_add_f32 v20, 1.0, v20
    v_rcp_f32 v20, v20
    s_nop 0
    v_mul_f32 v20, v20, v21
    v_cvt_pk_bf16_f32 v20, v20, v20
    v_lshlrev_b32 v13, 2, v1
    v_add_u32 v14, 14314, v13
    v_add_u32 v13, 14336, v13
    v_mov_b32 v15, 14836
    v_cmp_gt_u32 vcc, 6, v1
    s_nop 1
    v_cndmask_b32 v14, v14, v15, vcc
    v_cmp_le_u32 vcc, 48, v1
    s_nop 1
    v_cndmask_b32 v14, v14, v15, vcc
    v_cndmask_b32 v13, v13, v15, vcc
    ds_write_b16 v13, v20
    ds_write_b16 v14, v20
    s_waitcnt lgkmcnt(0)
L_bh_85:
    v_mov_b32 v120, 0
    v_mov_b32 v121, 0
    v_mov_b32 v122, 0
    v_mov_b32 v123, 0
    v_mov_b32 v124, 0
    v_mov_b32 v125, 0
    v_mov_b32 v126, 0
    v_mov_b32 v127, 0
    s_waitcnt vmcnt(0)
    s_mov_b32 s94, 0x05040100
    s_mov_b32 s95, 0x07060302
    v_perm_b32 v128, v164, v160, s94
    v_perm_b32 v164, v164, v160, s95
    v_mov_b32 v160, v128
    v_perm_b32 v128, v165, v161, s94
    v_perm_b32 v165, v165, v161, s95
    v_mov_b32 v161, v128
    v_perm_b32 v128, v166, v162, s94
    v_perm_b32 v166, v166, v162, s95
    v_mov_b32 v162, v128
    v_perm_b32 v128, v167, v163, s94
    v_perm_b32 v167, v167, v163, s95
    v_mov_b32 v163, v128
    v_perm_b32 v128, v172, v168, s94
    v_perm_b32 v172, v172, v168, s95
    v_mov_b32 v168, v128
    v_perm_b32 v128, v173, v169, s94
    v_perm_b32 v173, v173, v169, s95
    v_mov_b32 v169, v128
    v_perm_b32 v128, v174, v170, s94
    v_perm_b32 v174, v174, v170, s95
    v_mov_b32 v170, v128
    v_perm_b32 v128, v175, v171, s94
    v_perm_b32 v175, v175, v171, s95
    v_mov_b32 v171, v128
    v_perm_b32 v128, v180, v176, s94
    v_perm_b32 v180, v180, v176, s95
    v_mov_b32 v176, v128
    v_perm_b32 v128, v181, v177, s94
    v_perm_b32 v181, v181, v177, s95
    v_mov_b32 v177, v128
    v_perm_b32 v128, v182, v178, s94
    v_perm_b32 v182, v182, v178, s95
    v_mov_b32 v178, v128
    v_perm_b32 v128, v183, v179, s94
    v_perm_b32 v183, v183, v179, s95
    v_mov_b32 v179, v128
    v_perm_b32 v128, v188, v184, s94
    v_perm_b32 v188, v188, v184, s95
    v_mov_b32 v184, v128
    v_perm_b32 v128, v189, v185, s94
    v_perm_b32 v189, v189, v185, s95
    v_mov_b32 v185, v128
    v_perm_b32 v128, v190, v186, s94
    v_perm_b32 v190, v190, v186, s95
    v_mov_b32 v186, v128
    v_perm_b32 v128, v191, v187, s94
    v_perm_b32 v191, v191, v187, s95
    v_mov_b32 v187, v128
    s_barrier
    ds_read_b32 v100, v19 offset:14336
    ds_read_b32 v101, v19 offset:14384
    ds_read_b32 v102, v19 offset:14432
    ds_read_b32 v103, v19 offset:14480
    s_waitcnt lgkmcnt(0)
    v_dot2c_f32_bf16 v120, v160, v100
    v_dot2c_f32_bf16 v122, v161, v100
    v_dot2c_f32_bf16 v124, v162, v100
    v_dot2c_f32_bf16 v126, v163, v100
    v_dot2c_f32_bf16 v121, v164, v100
    v_dot2c_f32_bf16 v123, v165, v100
    v_dot2c_f32_bf16 v125, v166, v100
    v_dot2c_f32_bf16 v127, v167, v100
    v_dot2c_f32_bf16 v120, v168, v101
    v_dot2c_f32_bf16 v122, v169, v101
    v_dot2c_f32_bf16 v124, v170, v101
    v_dot2c_f32_bf16 v126, v171, v101
    v_dot2c_f32_bf16 v121, v172, v101
    v_dot2c_f32_bf16 v123, v173, v101
    v_dot2c_f32_bf16 v125, v174, v101
    v_dot2c_f32_bf16 v127, v175, v101
    v_dot2c_f32_bf16 v120, v176, v102
    v_dot2c_f32_bf16 v122, v177, v102
    v_dot2c_f32_bf16 v124, v178, v102
    v_dot2c_f32_bf16 v126, v179, v102
    v_dot2c_f32_bf16 v121, v180, v102
    v_dot2c_f32_bf16 v123, v181, v102
    v_dot2c_f32_bf16 v125, v182, v102
    v_dot2c_f32_bf16 v127, v183, v102
    v_dot2c_f32_bf16 v120, v184, v103
    v_dot2c_f32_bf16 v122, v185, v103
    v_dot2c_f32_bf16 v124, v186, v103
    v_dot2c_f32_bf16 v126, v187, v103
    v_dot2c_f32_bf16 v121, v188, v103
    v_dot2c_f32_bf16 v123, v189, v103
    v_dot2c_f32_bf16 v125, v190, v103
    v_dot2c_f32_bf16 v127, v191, v103
    s_nop 2
    ds_write_b128 v129, v[120:123] offset:16384
    ds_write_b128 v129, v[124:127] offset:16400
    s_waitcnt lgkmcnt(0)
    s_barrier
    s_cmp_ge_u32 s3, 3
    s_cbranch_scc1 L_go_86
    ds_read_b128 v[132:135], v131 offset:16384
    ds_read_b128 v[136:139], v131 offset:18944
    ds_read_b128 v[140:143], v131 offset:21504
    ds_read_b128 v[144:147], v131 offset:24064
    ds_read_b128 v[148:151], v131 offset:26624
    ds_read_b128 v[152:155], v131 offset:29184
    s_waitcnt lgkmcnt(0)
    v_add_f32 v132, v132, v136
    v_add_f32 v140, v140, v144
    v_add_f32 v148, v148, v152
    v_add_f32 v133, v133, v137
    v_add_f32 v141, v141, v145
    v_add_f32 v149, v149, v153
    v_add_f32 v134, v134, v138
    v_add_f32 v142, v142, v146
    v_add_f32 v150, v150, v154
    v_add_f32 v135, v135, v139
    v_add_f32 v143, v143, v147
    v_add_f32 v151, v151, v155
    v_add_f32 v132, v132, v140
    v_add_f32 v133, v133, v141
    v_add_f32 v134, v134, v142
    v_add_f32 v135, v135, v143
    v_add_f32 v132, v132, v148
    v_add_f32 v133, v133, v149
    v_add_f32 v134, v134, v150
    v_add_f32 v135, v135, v151
    v_min_u32 v132, 0xfffffffe, v132
    v_min_u32 v133, 0xfffffffe, v133
    v_min_u32 v134, 0xfffffffe, v134
    v_min_u32 v135, 0xfffffffe, v135
    buffer_store_dwordx4 v[132:135], v130, s[64:67], s84 offen sc1
L_go_86:
L_aend:
    s_branch L_exit
L_bfin:
    s_cmp_ge_u32 s10, 5
    s_cbranch_scc1 L_bend
    v_lshlrev_b32 v5, 2, v1
    buffer_load_dword v20, v5, s[16:19], 0 offen offset:0
    buffer_load_dword v25, v5, s[56:59], 0 offen offset:0
    buffer_load_dword v21, v5, s[16:19], 0 offen offset:256
    buffer_load_dword v26, v5, s[56:59], 0 offen offset:256
    buffer_load_dword v22, v5, s[16:19], 0 offen offset:512
    buffer_load_dword v27, v5, s[56:59], 0 offen offset:512
    buffer_load_dword v23, v5, s[16:19], 0 offen offset:768
    buffer_load_dword v28, v5, s[56:59], 0 offen offset:768
    buffer_load_dword v24, v5, s[16:19], 0 offen offset:1024
    buffer_load_dword v29, v5, s[56:59], 0 offen offset:1024
    v_mov_b32 v30, 0
    s_waitcnt vmcnt(0)
    v_dot2c_f32_bf16 v30, v20, v25
    v_dot2c_f32_bf16 v30, v21, v26
    v_dot2c_f32_bf16 v30, v22, v27
    v_dot2c_f32_bf16 v30, v23, v28
    v_dot2c_f32_bf16 v30, v24, v29
    s_nop 2
    v_add_f32_dpp v30, v30, v30 quad_perm:[1,0,3,2] row_mask:0xf bank_mask:0xf
    s_nop 1
    v_add_f32_dpp v30, v30, v30 quad_perm:[2,3,0,1] row_mask:0xf bank_mask:0xf
    s_nop 1
    v_add_f32_dpp v30, v30, v30 row_half_mirror row_mask:0xf bank_mask:0xf
    s_nop 1
    v_add_f32_dpp v30, v30, v30 row_mirror row_mask:0xf bank_mask:0xf
    s_nop 1
    v_mov_b32 v31, v30
    s_nop 1
    v_permlane16_swap_b32 v30, v31
    s_nop 1
    v_add_f32 v30, v30, v31
    v_mov_b32 v31, v30
    s_nop 1
    v_permlane32_swap_b32 v30, v31
    s_nop 1
    v_add_f32 v30, v30, v31
    v_mul_f32 v30, 0xbfb8aa3b, v30
    v_exp_f32 v30, v30
    s_nop 0
    v_add_f32 v30, 1.0, v30
    v_rcp_f32 v30, v30
    s_nop 0
    v_sub_f32 v31, 1.0, v30
    v_cmp_le_u32 vcc, 48, v1
    s_nop 1
    v_cndmask_b32 v30, v30, v31, vcc
    s_mul_i32 s74, s4, 5
    s_add_u32 s74, s74, s10
    s_lshl_b32 s75, s74, 6
    s_add_u32 s75, s75, 2424832
    v_lshrrev_b32 v6, 2, v0
    v_mul_u32_u24 v6, 2560, v6
    v_and_b32 v7, 3, v0
    v_lshl_add_u32 v6, v7, 4, v6
    v_and_b32 v8, 3, v1
    v_lshlrev_b32 v8, 2, v8
    v_bfe_u32 v9, v1, 5, 1
    v_lshl_add_u32 v8, v9, 1, v8
    v_bfe_u32 v9, v1, 4, 1
    v_add_u32 v8, v8, v9
    v_lshlrev_b32 v8, 2, v8
    s_lshl_b32 s76, s3, 6
    v_add_u32 v10, s76, v8
    v_and_b32 v11, 15, v1
    v_lshlrev_b32 v12, 2, v11
    v_lshlrev_b32 v11, 1, v11
    v_mov_b32 v9, 0x7fffffff
    v_cmp_gt_u32 vcc, 16, v1
    s_lshl_b32 s76, s74, 5
    s_nop 0
    v_cndmask_b32 v11, v9, v11, vcc
    s_mov_b32 s96, 0
L_poll_87:
    buffer_load_dwordx4 v[32:35], v6, s[64:67], s75 offen sc1
    s_waitcnt vmcnt(0)
    v_max3_u32 v8, v32, v33, v34
    v_max_u32 v8, v8, v35
    v_cmp_eq_u32 vcc, -1, v8
    s_nop 1
    v_cndmask_b32 v8, 0, 1, vcc
    v_cmp_ne_u32 vcc, 0, v8
    s_cbranch_vccz L_ok_88
    s_add_u32 s96, s96, 1
    s_cmp_lt_u32 s96, 100000
    s_cbranch_scc1 L_poll_87
L_ok_88:
    v_mul_f32 v32, v32, v30
    v_mul_f32 v33, v33, v30
    v_mul_f32 v34, v34, v30
    v_mul_f32 v35, v35, v30
    s_nop 1
    v_permlane32_swap_b32 v32, v34
    v_permlane32_swap_b32 v33, v35
    s_nop 1
    v_add_f32 v32, v32, v34
    v_add_f32 v33, v33, v35
    s_nop 1
    v_permlane16_swap_b32 v32, v33
    s_nop 1
    v_add_f32 v32, v32, v33
    s_nop 1
    v_add_f32_dpp v32, v32, v32 row_ror:8 row_mask:0xf bank_mask:0xf
    s_nop 1
    v_add_f32_dpp v32, v32, v32 row_ror:4 row_mask:0xf bank_mask:0xf
    ds_write_b32 v10, v32 offset:3072
    s_waitcnt lgkmcnt(0)
    s_barrier
    s_cmp_lg_u32 s3, 0
    s_cbranch_scc1 L_bend
    ds_read_b32 v40, v12 offset:3072
    ds_read_b32 v41, v12 offset:3136
    ds_read_b32 v42, v12 offset:3200
    ds_read_b32 v43, v12 offset:3264
    ds_read_b32 v44, v12 offset:3328
    ds_read_b32 v45, v12 offset:3392
    ds_read_b32 v46, v12 offset:3456
    ds_read_b32 v47, v12 offset:3520
    s_waitcnt lgkmcnt(0)
    v_add_f32 v40, v40, v41
    v_add_f32 v42, v42, v43
    v_add_f32 v44, v44, v45
    v_add_f32 v46, v46, v47
    v_add_f32 v40, v40, v42
    v_add_f32 v44, v44, v46
    v_add_f32 v40, v40, v44
    v_cvt_pk_bf16_f32 v40, v40, v40
    buffer_store_short v40, v11, s[60:63], s76 offen
    s_cmp_lg_u32 s74, 0
    s_cbranch_scc1 L_noep_89
    v_mov_b32 v6, s8
    v_mov_b32 v7, 0
    s_mov_b64 exec, 1
    buffer_store_dword v6, v7, s[64:67], 0 offen sc1
    s_mov_b64 exec, -1
L_noep_89:
L_bend:
L_exit:
    s_endpgm
.section .rodata,"a"
.p2align 6
.amdhsa_kernel gated_mix__compressed_kv_cla__glu_gated_glu__decode_kernel
  .amdhsa_next_free_vgpr 256
  .amdhsa_next_free_sgpr 102
  .amdhsa_accum_offset 256
  .amdhsa_group_segment_fixed_size 0
  .amdhsa_kernarg_size 112
  .amdhsa_user_sgpr_count 2
  .amdhsa_user_sgpr_kernarg_segment_ptr 1
  .amdhsa_system_sgpr_workgroup_id_x 1
.end_amdhsa_kernel
```
